```python
import torch

def _softmax(x, axis=-1):
    return torch.softmax(x, dim=axis)
def _gelu(x):
    return torch.nn.functional.gelu(x, approximate="tanh")
def _silu(x):
    return torch.nn.functional.silu(x)
def _sigmoid(x):
    return torch.sigmoid(x)
def _layernorm(x, axis=-1, eps=1e-5):
    m = x.mean(dim=axis, keepdim=True)
    v = x.var(dim=axis, keepdim=True, unbiased=False)
    return (x - m) / torch.sqrt(v + eps)
def _scatter_add(tgt, idx, src, axis=0):
    return tgt.clone().index_add_(axis, idx, src)
def _segment_sum(src, seg, n):
    out = torch.zeros((n,) + src.shape[1:], dtype=src.dtype)
    return out.index_add_(0, seg, src)
def _pad(x, pw):
    flat = tuple(v for pair in reversed(pw) for v in pair)
    return torch.nn.functional.pad(x, flat)

kernel_name = 'recurrent_scan__mha_block__swiglu_ffn__prompt'

def setup_inputs():

    _w = (lambda a: (lambda t: t.to(torch.bfloat16) if t.is_floating_point() else t)(torch.as_tensor(a)))
    def _A_setup():
        B, S, D, H = 1, 2048, 448, 16
        return {
            "x": _w((lambda *s: torch.randn(*s, dtype=torch.bfloat16) * 0.05)(B, S, D)),
            "wqkv": _w((lambda *s: torch.randn(*s, dtype=torch.bfloat16) * 0.05)(D, 3 * D)),
            "wo": _w((lambda *s: torch.randn(*s, dtype=torch.bfloat16) * 0.05)(D, D)),
        }
    _A_in = _A_setup()

    def _B_setup():
        B, S, D, F = 1, 2048, 448, 1792
        return {
            "x": _w((lambda *s: torch.randn(*s, dtype=torch.bfloat16) * 0.05)(B, S, D)),
            "w_gate": _w((lambda *s: torch.randn(*s, dtype=torch.bfloat16) * 0.05)(D, F)),
            "w_up": _w((lambda *s: torch.randn(*s, dtype=torch.bfloat16) * 0.05)(D, F)),
            "w_down": _w((lambda *s: torch.randn(*s, dtype=torch.bfloat16) * 0.05)(F, D)),
        }
    _B_in = _B_setup()

    return {
        "A_x": _A_in["x"],
        "A_wqkv": _A_in["wqkv"],
        "A_wo": _A_in["wo"],
        "B_x": _B_in["x"],
        "B_w_gate": _B_in["w_gate"],
        "B_w_up": _B_in["w_up"],
        "B_w_down": _B_in["w_down"],
    }

def reference(A_x, A_wqkv, A_wo, B_x, B_w_gate, B_w_up, B_w_down):
    def _A_ref(x, wqkv, wo):
        B, S, D = x.shape
        H = 16
        Dh = D // H
        qkv = (lambda x, *d: x.permute(*d))((x @ wqkv).reshape(B, S, 3, H, Dh), 2, 0, 3, 1, 4)
        q, k, v = qkv[0], qkv[1], qkv[2]
        scores = torch.einsum("bhqd,bhkd->bhqk", q, k) * (Dh ** -0.5)
        p = _softmax(scores, axis=-1)
        o = torch.einsum("bhqk,bhkd->bhqd", p, v)
        return (lambda x, *d: x.permute(*d))(o, 0, 2, 1, 3).reshape(B, S, D) @ wo

    def _B_ref(x, w_gate, w_up, w_down):
        g = _silu(x @ w_gate)
        u = x @ w_up
        return (g * u) @ w_down

    x = A_x
    xn = _layernorm(x, axis=-1)
    s = _A_ref(xn, A_wqkv, A_wo)
    g = _silu(_B_ref(xn, B_w_gate, B_w_up, B_w_down))
    return x + s * g
```

```asm
; @launch kernel=f_kernel grid=(256,1,1) block=(256,1,1) lds=163840
.amdgcn_target "amdgcn-amd-amdhsa--gfx950"
.text
.globl f_kernel
.p2align 8
.type f_kernel,@function
f_kernel:
s_cmp_ge_u32 s2, 256
s_cbranch_scc1 F_END
s_load_dwordx2 s[4:5], s[0:1], 0
s_load_dwordx2 s[12:13], s[0:1], 8
s_load_dwordx4 s[68:71], s[0:1], 32
s_load_dwordx2 s[16:17], s[0:1], 72
s_load_dwordx2 s[64:65], s[0:1], 48
s_load_dwordx2 s[66:67], s[0:1], 16
s_load_dwordx2 s[28:29], s[0:1], 56
s_load_dwordx2 s[32:33], s[0:1], 64
v_lshrrev_b32 v1, 6, v0
v_and_b32 v13, 63, v0
v_readfirstlane_b32 s40, v1
s_getpc_b64 s[36:37]
s_and_b32 s36, s36, 0xffffff00
s_lshr_b32 s38, s2, 3
s_lshl_b32 s38, s38, 2
s_add_u32 s38, s38, s40
s_lshl_b32 s38, s38, 6
v_and_b32 v2, 63, v0
v_add_u32 v2, s38, v2
v_lshlrev_b32 v2, 7, v2
v_and_b32 v2, 0xffff, v2
v_min_u32 v2, F_CODE_END-f_kernel-4, v2
v_mov_b32 v3, s37
v_add_co_u32 v2, vcc, s36, v2
s_nop 1
v_addc_co_u32 v3, vcc, 0, v3, vcc
global_load_dword v4, v[2:3], off
s_bfe_u32 s41, s2, 65536
s_lshl_b32 s41, s41, 3
s_bfe_u32 s36, s2, 196611
s_add_u32 s41, s41, s36
s_bfe_u32 s42, s2, 131073
s_lshl_b32 s42, s42, 2
s_lshr_b32 s36, s2, 6
s_add_u32 s42, s42, s36
s_mov_b32 s6, 1835008
s_mov_b32 s7, 0x00020000
v_lshrrev_b32 v14, 3, v13
v_lshrrev_b32 v15, 4, v13
v_and_b32 v9, 7, v13
v_xor_b32 v10, v9, v15
v_lshlrev_b32 v10, 4, v10
v_mul_u32_u24 v11, 896, v14
v_add_u32 v128, v10, v11
v_xor_b32 v129, 64, v128
v_add_u32 v130, 14336, v128
v_add_u32 v129, 7168, v129
v_add_u32 v131, 14336, v129
s_lshl_b32 s48, s41, 2
s_add_u32 s48, s48, s40
s_mul_i32 s37, s48, 28672
s_mul_i32 s62, s40, 28672
s_add_u32 s62, s62, 49152
s_bfe_u32 s3, s2, 196611
s_mul_i32 s3, s3, 1
s_lshr_b32 s38, s2, 6
s_mul_i32 s38, s38, 2
s_add_u32 s3, s3, s38
s_mul_i32 s38, s3, 9363
s_lshr_b32 s38, s38, 16
s_mul_i32 s38, s38, 7
s_sub_u32 s3, s3, s38
s_lshl_b32 s38, s3, 7
s_add_u32 s39, s37, s38
s_add_u32 s38, s38, 128
s_cmp_eq_u32 s38, 896
s_cselect_b32 s38, 0, s38
s_add_u32 m0, s62, 0
s_waitcnt lgkmcnt(0)
buffer_load_dwordx4 v128, s[4:7], s39 offen lds
s_add_u32 m0, s62, 1024
s_nop 0
buffer_load_dwordx4 v129, s[4:7], s39 offen lds
s_add_u32 m0, s62, 2048
s_nop 0
buffer_load_dwordx4 v130, s[4:7], s39 offen lds
s_add_u32 m0, s62, 3072
s_nop 0
buffer_load_dwordx4 v131, s[4:7], s39 offen lds
s_add_u32 s39, s37, s38
s_add_u32 s38, s38, 128
s_cmp_eq_u32 s38, 896
s_cselect_b32 s38, 0, s38
s_add_u32 m0, s62, 4096
s_nop 0
buffer_load_dwordx4 v128, s[4:7], s39 offen lds
s_add_u32 m0, s62, 5120
s_nop 0
buffer_load_dwordx4 v129, s[4:7], s39 offen lds
s_add_u32 m0, s62, 6144
s_nop 0
buffer_load_dwordx4 v130, s[4:7], s39 offen lds
s_add_u32 m0, s62, 7168
s_nop 0
buffer_load_dwordx4 v131, s[4:7], s39 offen lds
s_add_u32 s39, s37, s38
s_add_u32 s38, s38, 128
s_cmp_eq_u32 s38, 896
s_cselect_b32 s38, 0, s38
s_add_u32 m0, s62, 8192
s_nop 0
buffer_load_dwordx4 v128, s[4:7], s39 offen lds
s_add_u32 m0, s62, 9216
s_nop 0
buffer_load_dwordx4 v129, s[4:7], s39 offen lds
s_add_u32 m0, s62, 10240
s_nop 0
buffer_load_dwordx4 v130, s[4:7], s39 offen lds
s_add_u32 m0, s62, 11264
s_nop 0
buffer_load_dwordx4 v131, s[4:7], s39 offen lds
s_add_u32 s39, s37, s38
s_add_u32 s38, s38, 128
s_cmp_eq_u32 s38, 896
s_cselect_b32 s38, 0, s38
s_add_u32 m0, s62, 12288
s_nop 0
buffer_load_dwordx4 v128, s[4:7], s39 offen lds
s_add_u32 m0, s62, 13312
s_nop 0
buffer_load_dwordx4 v129, s[4:7], s39 offen lds
s_add_u32 m0, s62, 14336
s_nop 0
buffer_load_dwordx4 v130, s[4:7], s39 offen lds
s_add_u32 m0, s62, 15360
s_nop 0
buffer_load_dwordx4 v131, s[4:7], s39 offen lds
s_add_u32 s39, s37, s38
s_add_u32 s38, s38, 128
s_cmp_eq_u32 s38, 896
s_cselect_b32 s38, 0, s38
s_add_u32 m0, s62, 16384
s_nop 0
buffer_load_dwordx4 v128, s[4:7], s39 offen lds
s_add_u32 m0, s62, 17408
s_nop 0
buffer_load_dwordx4 v129, s[4:7], s39 offen lds
s_add_u32 m0, s62, 18432
s_nop 0
buffer_load_dwordx4 v130, s[4:7], s39 offen lds
s_add_u32 m0, s62, 19456
s_nop 0
buffer_load_dwordx4 v131, s[4:7], s39 offen lds
s_add_u32 s39, s37, s38
s_add_u32 s38, s38, 128
s_cmp_eq_u32 s38, 896
s_cselect_b32 s38, 0, s38
s_add_u32 m0, s62, 20480
s_nop 0
buffer_load_dwordx4 v128, s[4:7], s39 offen lds
s_add_u32 m0, s62, 21504
s_nop 0
buffer_load_dwordx4 v129, s[4:7], s39 offen lds
s_add_u32 m0, s62, 22528
s_nop 0
buffer_load_dwordx4 v130, s[4:7], s39 offen lds
s_add_u32 m0, s62, 23552
s_nop 0
buffer_load_dwordx4 v131, s[4:7], s39 offen lds
s_add_u32 s39, s37, s38
s_add_u32 s38, s38, 128
s_cmp_eq_u32 s38, 896
s_cselect_b32 s38, 0, s38
s_add_u32 m0, s62, 24576
s_nop 0
buffer_load_dwordx4 v128, s[4:7], s39 offen lds
s_add_u32 m0, s62, 25600
s_nop 0
buffer_load_dwordx4 v129, s[4:7], s39 offen lds
s_add_u32 m0, s62, 26624
s_nop 0
buffer_load_dwordx4 v130, s[4:7], s39 offen lds
s_add_u32 m0, s62, 27648
s_nop 0
buffer_load_dwordx4 v131, s[4:7], s39 offen lds
v_and_b32 v10, 1, v15
v_lshlrev_b32 v10, 2, v10
v_xor_b32 v10, v9, v10
v_cmp_le_u32 vcc, 4, v10
v_lshlrev_b32 v10, 4, v10
s_and_b32 s36, s40, 1
s_lshr_b32 s37, s40, 1
s_cmp_eq_u32 s37, 0
s_movk_i32 s38, 832
s_cselect_b32 s38, s38, 0x80000000
s_cselect_b32 s8, s68, s70
s_cselect_b32 s9, s69, s71
v_mov_b32 v12, s38
v_cndmask_b32 v12, 0, v12, vcc
v_mul_u32_u24 v8, 2688, v14
v_add3_u32 v8, v8, v10, v12
s_mul_i32 s46, s42, 56
s_and_b32 s46, s46, -16
s_mul_i32 s38, s36, 21504
s_add_u32 s46, s46, s38
s_mul_i32 s38, s37, 1792
s_add_u32 s0, s46, s38
s_mul_i32 s38, s3, 172032
s_add_u32 s46, s0, s38
s_mul_i32 s1, s3, 229376
s_lshl_b32 s43, s40, 10
s_lshl_b32 s38, s37, 5
s_add_u32 s43, s43, s38
s_mov_b32 s14, 1204224
s_mov_b32 s15, 0x00020000
s_add_u32 m0, s43, 0
s_nop 0
buffer_load_dwordx4 v8, s[12:15], s46 offen lds
s_add_u32 s46, s46, 43008
s_add_u32 m0, s43, 4128
s_nop 0
buffer_load_dwordx4 v8, s[12:15], s46 offen lds
s_add_u32 s46, s46, 43008
s_add_u32 m0, s43, 8256
s_nop 0
buffer_load_dwordx4 v8, s[12:15], s46 offen lds
s_add_u32 s46, s46, 43008
s_add_u32 m0, s43, 12384
s_nop 0
buffer_load_dwordx4 v8, s[12:15], s46 offen lds
s_add_u32 s46, s46, 43008
s_sub_u32 s3, s46, 1204224
s_cmp_eq_u32 s3, s0
s_cselect_b32 s46, s0, s46
s_add_u32 m0, s43, 16512
s_nop 0
buffer_load_dwordx4 v8, s[12:15], s46 offen lds
s_add_u32 s46, s46, 43008
s_add_u32 m0, s43, 20640
s_nop 0
buffer_load_dwordx4 v8, s[12:15], s46 offen lds
s_add_u32 s46, s46, 43008
s_add_u32 m0, s43, 24768
s_nop 0
buffer_load_dwordx4 v8, s[12:15], s46 offen lds
s_add_u32 s46, s46, 43008
s_add_u32 m0, s43, 28896
s_nop 0
buffer_load_dwordx4 v8, s[12:15], s46 offen lds
s_add_u32 s46, s46, 43008
s_sub_u32 s3, s46, 1204224
s_cmp_eq_u32 s3, s0
s_cselect_b32 s46, s0, s46
s_mov_b32 s10, 1605632
s_mov_b32 s11, 0x00020000
s_mov_b32 s18, 268435456
s_mov_b32 s19, 0x00020000
s_mov_b32 s30, 1835008
s_mov_b32 s31, 0x00020000
s_mov_b32 s34, 256
s_mov_b32 s35, 0x00020000
v_mul_u32_u24 v7, 3584, v14
v_add_u32 v7, v7, v10
v_mul_u32_u24 v150, 896, v14
v_add_u32 v150, v150, v10
v_cmp_le_u32 vcc, 0x60, v10
v_bfrev_b32 v12, 1
s_nop 0
v_cndmask_b32 v14, v7, v12, vcc
s_lshl_b32 s47, s42, 7
s_mul_i32 s38, s36, 28672
s_add_u32 s47, s47, s38
s_lshr_b32 s61, s42, 2
s_xor_b32 s61, s61, s42
s_bfe_u32 s61, s61, 0x10001
s_xor_b32 s61, s61, s42
s_mul_i32 s61, s61, 96
s_add_u32 s61, s61, s38
s_add_u32 s61, s61, 2048
v_and_b32 v140, 31, v13
v_lshrrev_b32 v141, 5, v13
v_lshlrev_b32 v0, 4, v13
v_bfe_u32 v142, v13, 2, 2
v_lshl_add_u32 v143, v141, 3, v142
v_lshlrev_b32 v143, 7, v143
v_bfe_u32 v144, v13, 4, 1
v_bfe_u32 v145, v13, 3, 1
v_lshlrev_b32 v145, 6, v145
v_and_b32 v146, 3, v13
v_lshlrev_b32 v147, 3, v146
v_xor_b32 v147, v147, v145
v_add_u32 v147, v147, v143
v_mul_u32_u24 v148, 2080, v144
v_add_u32 v1, v147, v148
v_xor_b32 v147, 64, v147
v_add_u32 v2, v147, v148
v_lshl_add_u32 v146, v144, 2, v146
v_lshlrev_b32 v147, 3, v146
v_xor_b32 v147, v147, v145
v_add_u32 v147, v147, v143
v_lshlrev_b32 v148, 9, v141
v_sub_u32 v148, v147, v148
s_lshl_b32 s38, s40, 11
s_add_u32 s63, s38, 152736
v_xor_b32 v149, 64, v148
v_add_u32 v148, s63, v148
v_add_u32 v149, s63, v149
s_and_b32 s38, s42, 1
v_add_u32 v146, s38, v146
v_and_b32 v146, 7, v146
v_lshlrev_b32 v147, 3, v146
v_xor_b32 v147, v147, v145
v_add_u32 v248, v147, v143
v_xor_b32 v249, 64, v248
v_add_u32 v250, 61920, v248
v_add_u32 v251, 61920, v249
v_add_u32 v3, 61920, v1
s_waitcnt vmcnt(36)
v_add_u32 v4, 61920, v2
v_add_u32 v5, 123840, v1
v_add_u32 v6, 123840, v2
v_bfe_u32 v142, v13, 1, 3
v_xor_b32 v142, v142, v141
v_lshlrev_b32 v142, 4, v142
v_lshl_add_u32 v142, v140, 7, v142
v_add_u32 v132, s62, v142
v_xor_b32 v133, 32, v132
v_xor_b32 v134, 64, v132
v_xor_b32 v135, 0x60, v132
v_mov_b32 v136, 0
v_mov_b32 v137, 0
v_mov_b32 v138, 0
v_mov_b32 v139, 0
s_mov_b32 s60, 0x3f803f80
v_cmp_gt_u32 s[44:45], 32, v13
s_lshl_b32 s38, s2, 2
s_add_u32 s38, s38, s40
s_lshl_b32 s52, s38, 11
s_add_u32 s52, s52, 13631488
s_mul_i32 s39, s38, 9363
s_lshr_b32 s39, s39, 20
s_mul_i32 s53, s39, 112
s_sub_u32 s53, s38, s53
s_mul_i32 s54, s53, 9363
s_lshr_b32 s54, s54, 16
s_mul_i32 s55, s54, 7
s_sub_u32 s55, s53, s55
s_lshr_b32 s53, s54, 2
s_xor_b32 s53, s53, s54
s_bfe_u32 s56, s53, 0x10001
s_lshl_b32 s53, s54, 2
s_xor_b32 s54, s54, s56
s_mul_i32 s54, s54, 3
s_add_u32 s54, s54, 60
s_cmp_lt_u32 s55, 4
s_cselect_b32 s53, s53, s54
s_add_u32 s53, s53, s55
s_mul_i32 s53, s53, 14336
s_lshl_b32 s39, s39, 7
s_add_u32 s53, s53, s39
s_sub_u32 s39, s38, 784
s_bfe_u32 s54, s39, 0x40001
s_mul_i32 s54, s54, 25088
s_and_b32 s55, s39, 1
s_mul_i32 s55, s55, 14336
s_add_u32 s54, s54, s55
s_lshr_b32 s39, s39, 5
s_lshl_b32 s39, s39, 7
s_add_u32 s54, s54, s39
s_cmp_lt_u32 s38, 784
s_cselect_b32 s53, s53, s54
s_cselect_b32 s54, 2, 0
s_cselect_b32 s20, s64, s66
s_cselect_b32 s21, s65, s67
s_lshl_b32 s22, 401408, s54
s_mov_b32 s23, 0x00020000
v_add_u32 v150, s53, v150
v_add_u32 v151, 7168, v150
s_lshr_b32 s38, s48, 1
s_mul_i32 s49, s38, 229376
s_mul_i32 s39, s42, 14336
s_add_u32 s49, s49, s39
s_lshl_b32 s39, s36, 10
s_add_u32 s49, s49, s39
s_add_u32 s49, s49, 6291456
s_lshl_b32 s54, s38, 16
s_add_u32 s54, s54, s39
s_lshl_b32 s39, s42, 12
s_add_u32 s54, s54, s39
s_add_u32 s54, s54, 16777216
s_lshl_b32 s55, s38, 4
s_add_u32 s55, s55, s42
s_lshl_b32 s55, s55, 1
s_add_u32 s55, s55, s36
s_lshl_b32 s55, s55, 7
s_add_u32 s55, s55, 18874368
s_lshl_b32 s50, s42, 6
s_add_u32 s50, s50, s48
s_lshl_b32 s51, s50, 12
s_add_u32 s51, s51, 2097152
s_lshl_b32 s50, s50, 11
v_lshlrev_b32 v15, 2, v13
v_cndmask_b32 v15, v12, v15, s[44:45]
v_cmp_eq_u32 vcc, 0, v13
s_nop 1
v_cndmask_b32 v11, v12, v13, vcc
s_bfe_u32 s59, s2, 3
s_lshl_b32 s38, s59, 8
s_lshl_b32 s59, s59, 2
s_add_u32 s59, s59, 19922944
s_lshl_b32 s58, s2, 7
s_add_u32 s58, s58, 19922944
s_cmp_eq_u32 s40, 0
s_cselect_b32 s38, s38, 0x80000000
v_or_b32 v11, s38, v11
v_cmp_eq_u32 s[38:39], 28, v140
s_waitcnt vmcnt(32)
ds_read_b128 v[16:19], v132 offset:0
ds_read_b128 v[20:23], v133 offset:0
ds_read_b128 v[24:27], v134 offset:0
ds_read_b128 v[28:31], v135 offset:0
s_waitcnt vmcnt(28)
ds_read_b128 v[32:35], v132 offset:4096
ds_read_b128 v[36:39], v133 offset:4096
ds_read_b128 v[40:43], v134 offset:4096
ds_read_b128 v[44:47], v135 offset:4096
s_waitcnt lgkmcnt(7)
v_dot2c_f32_bf16 v136, s60, v16
v_dot2c_f32_bf16 v138, v16, v16
v_dot2c_f32_bf16 v137, s60, v17
v_dot2c_f32_bf16 v139, v17, v17
v_dot2c_f32_bf16 v136, s60, v18
v_dot2c_f32_bf16 v138, v18, v18
v_dot2c_f32_bf16 v137, s60, v19
v_dot2c_f32_bf16 v139, v19, v19
s_waitcnt lgkmcnt(6)
v_dot2c_f32_bf16 v136, s60, v20
v_dot2c_f32_bf16 v138, v20, v20
v_dot2c_f32_bf16 v137, s60, v21
v_dot2c_f32_bf16 v139, v21, v21
v_dot2c_f32_bf16 v136, s60, v22
v_dot2c_f32_bf16 v138, v22, v22
v_dot2c_f32_bf16 v137, s60, v23
v_dot2c_f32_bf16 v139, v23, v23
s_waitcnt lgkmcnt(5)
v_dot2c_f32_bf16 v136, s60, v24
v_dot2c_f32_bf16 v138, v24, v24
v_dot2c_f32_bf16 v137, s60, v25
v_dot2c_f32_bf16 v139, v25, v25
v_dot2c_f32_bf16 v136, s60, v26
v_dot2c_f32_bf16 v138, v26, v26
v_dot2c_f32_bf16 v137, s60, v27
v_dot2c_f32_bf16 v139, v27, v27
s_waitcnt lgkmcnt(4)
v_dot2c_f32_bf16 v136, s60, v28
v_dot2c_f32_bf16 v138, v28, v28
v_dot2c_f32_bf16 v137, s60, v29
v_dot2c_f32_bf16 v139, v29, v29
v_dot2c_f32_bf16 v136, s60, v30
v_dot2c_f32_bf16 v138, v30, v30
v_dot2c_f32_bf16 v137, s60, v31
v_dot2c_f32_bf16 v139, v31, v31
s_waitcnt vmcnt(24)
ds_read_b128 v[48:51], v132 offset:8192
ds_read_b128 v[52:55], v133 offset:8192
ds_read_b128 v[56:59], v134 offset:8192
ds_read_b128 v[60:63], v135 offset:8192
s_waitcnt lgkmcnt(7)
v_dot2c_f32_bf16 v136, s60, v32
v_dot2c_f32_bf16 v138, v32, v32
v_dot2c_f32_bf16 v137, s60, v33
v_dot2c_f32_bf16 v139, v33, v33
v_dot2c_f32_bf16 v136, s60, v34
v_dot2c_f32_bf16 v138, v34, v34
v_dot2c_f32_bf16 v137, s60, v35
v_dot2c_f32_bf16 v139, v35, v35
s_waitcnt lgkmcnt(6)
v_dot2c_f32_bf16 v136, s60, v36
v_dot2c_f32_bf16 v138, v36, v36
v_dot2c_f32_bf16 v137, s60, v37
v_dot2c_f32_bf16 v139, v37, v37
v_dot2c_f32_bf16 v136, s60, v38
v_dot2c_f32_bf16 v138, v38, v38
v_dot2c_f32_bf16 v137, s60, v39
v_dot2c_f32_bf16 v139, v39, v39
s_waitcnt lgkmcnt(5)
v_dot2c_f32_bf16 v136, s60, v40
v_dot2c_f32_bf16 v138, v40, v40
v_dot2c_f32_bf16 v137, s60, v41
v_dot2c_f32_bf16 v139, v41, v41
v_dot2c_f32_bf16 v136, s60, v42
v_dot2c_f32_bf16 v138, v42, v42
v_dot2c_f32_bf16 v137, s60, v43
v_dot2c_f32_bf16 v139, v43, v43
s_waitcnt lgkmcnt(4)
v_dot2c_f32_bf16 v136, s60, v44
v_dot2c_f32_bf16 v138, v44, v44
v_dot2c_f32_bf16 v137, s60, v45
v_dot2c_f32_bf16 v139, v45, v45
v_dot2c_f32_bf16 v136, s60, v46
v_dot2c_f32_bf16 v138, v46, v46
v_dot2c_f32_bf16 v137, s60, v47
v_dot2c_f32_bf16 v139, v47, v47
s_waitcnt vmcnt(20)
ds_read_b128 v[64:67], v132 offset:12288
ds_read_b128 v[68:71], v133 offset:12288
ds_read_b128 v[72:75], v134 offset:12288
ds_read_b128 v[76:79], v135 offset:12288
s_waitcnt lgkmcnt(7)
v_dot2c_f32_bf16 v136, s60, v48
v_dot2c_f32_bf16 v138, v48, v48
v_dot2c_f32_bf16 v137, s60, v49
v_dot2c_f32_bf16 v139, v49, v49
v_dot2c_f32_bf16 v136, s60, v50
v_dot2c_f32_bf16 v138, v50, v50
v_dot2c_f32_bf16 v137, s60, v51
v_dot2c_f32_bf16 v139, v51, v51
s_waitcnt lgkmcnt(6)
v_dot2c_f32_bf16 v136, s60, v52
v_dot2c_f32_bf16 v138, v52, v52
v_dot2c_f32_bf16 v137, s60, v53
v_dot2c_f32_bf16 v139, v53, v53
v_dot2c_f32_bf16 v136, s60, v54
v_dot2c_f32_bf16 v138, v54, v54
v_dot2c_f32_bf16 v137, s60, v55
v_dot2c_f32_bf16 v139, v55, v55
s_waitcnt lgkmcnt(5)
v_dot2c_f32_bf16 v136, s60, v56
v_dot2c_f32_bf16 v138, v56, v56
v_dot2c_f32_bf16 v137, s60, v57
v_dot2c_f32_bf16 v139, v57, v57
v_dot2c_f32_bf16 v136, s60, v58
v_dot2c_f32_bf16 v138, v58, v58
v_dot2c_f32_bf16 v137, s60, v59
v_dot2c_f32_bf16 v139, v59, v59
s_waitcnt lgkmcnt(4)
v_dot2c_f32_bf16 v136, s60, v60
v_dot2c_f32_bf16 v138, v60, v60
v_dot2c_f32_bf16 v137, s60, v61
v_dot2c_f32_bf16 v139, v61, v61
v_dot2c_f32_bf16 v136, s60, v62
v_dot2c_f32_bf16 v138, v62, v62
v_dot2c_f32_bf16 v137, s60, v63
v_dot2c_f32_bf16 v139, v63, v63
s_waitcnt vmcnt(16)
ds_read_b128 v[80:83], v132 offset:16384
ds_read_b128 v[84:87], v133 offset:16384
ds_read_b128 v[88:91], v134 offset:16384
ds_read_b128 v[92:95], v135 offset:16384
s_waitcnt lgkmcnt(7)
v_dot2c_f32_bf16 v136, s60, v64
v_dot2c_f32_bf16 v138, v64, v64
v_dot2c_f32_bf16 v137, s60, v65
v_dot2c_f32_bf16 v139, v65, v65
v_dot2c_f32_bf16 v136, s60, v66
v_dot2c_f32_bf16 v138, v66, v66
v_dot2c_f32_bf16 v137, s60, v67
v_dot2c_f32_bf16 v139, v67, v67
s_waitcnt lgkmcnt(6)
v_dot2c_f32_bf16 v136, s60, v68
v_dot2c_f32_bf16 v138, v68, v68
v_dot2c_f32_bf16 v137, s60, v69
v_dot2c_f32_bf16 v139, v69, v69
v_dot2c_f32_bf16 v136, s60, v70
v_dot2c_f32_bf16 v138, v70, v70
v_dot2c_f32_bf16 v137, s60, v71
v_dot2c_f32_bf16 v139, v71, v71
s_waitcnt lgkmcnt(5)
v_dot2c_f32_bf16 v136, s60, v72
v_dot2c_f32_bf16 v138, v72, v72
v_dot2c_f32_bf16 v137, s60, v73
v_dot2c_f32_bf16 v139, v73, v73
v_dot2c_f32_bf16 v136, s60, v74
v_dot2c_f32_bf16 v138, v74, v74
v_dot2c_f32_bf16 v137, s60, v75
v_dot2c_f32_bf16 v139, v75, v75
s_waitcnt lgkmcnt(4)
v_dot2c_f32_bf16 v136, s60, v76
v_dot2c_f32_bf16 v138, v76, v76
v_dot2c_f32_bf16 v137, s60, v77
v_dot2c_f32_bf16 v139, v77, v77
v_dot2c_f32_bf16 v136, s60, v78
v_dot2c_f32_bf16 v138, v78, v78
v_dot2c_f32_bf16 v137, s60, v79
v_dot2c_f32_bf16 v139, v79, v79
s_waitcnt vmcnt(12)
ds_read_b128 v[96:99], v132 offset:20480
ds_read_b128 v[100:103], v133 offset:20480
ds_read_b128 v[104:107], v134 offset:20480
ds_read_b128 v[108:111], v135 offset:20480
s_waitcnt lgkmcnt(7)
v_dot2c_f32_bf16 v136, s60, v80
v_dot2c_f32_bf16 v138, v80, v80
v_dot2c_f32_bf16 v137, s60, v81
v_dot2c_f32_bf16 v139, v81, v81
v_dot2c_f32_bf16 v136, s60, v82
v_dot2c_f32_bf16 v138, v82, v82
v_dot2c_f32_bf16 v137, s60, v83
v_dot2c_f32_bf16 v139, v83, v83
s_waitcnt lgkmcnt(6)
v_dot2c_f32_bf16 v136, s60, v84
v_dot2c_f32_bf16 v138, v84, v84
v_dot2c_f32_bf16 v137, s60, v85
v_dot2c_f32_bf16 v139, v85, v85
v_dot2c_f32_bf16 v136, s60, v86
v_dot2c_f32_bf16 v138, v86, v86
v_dot2c_f32_bf16 v137, s60, v87
v_dot2c_f32_bf16 v139, v87, v87
s_waitcnt lgkmcnt(5)
v_dot2c_f32_bf16 v136, s60, v88
v_dot2c_f32_bf16 v138, v88, v88
v_dot2c_f32_bf16 v137, s60, v89
v_dot2c_f32_bf16 v139, v89, v89
v_dot2c_f32_bf16 v136, s60, v90
v_dot2c_f32_bf16 v138, v90, v90
v_dot2c_f32_bf16 v137, s60, v91
v_dot2c_f32_bf16 v139, v91, v91
s_waitcnt lgkmcnt(4)
v_dot2c_f32_bf16 v136, s60, v92
v_dot2c_f32_bf16 v138, v92, v92
v_dot2c_f32_bf16 v137, s60, v93
v_dot2c_f32_bf16 v139, v93, v93
v_dot2c_f32_bf16 v136, s60, v94
v_dot2c_f32_bf16 v138, v94, v94
v_dot2c_f32_bf16 v137, s60, v95
v_dot2c_f32_bf16 v139, v95, v95
s_waitcnt vmcnt(8)
ds_read_b128 v[112:115], v132 offset:24576
ds_read_b128 v[116:119], v133 offset:24576
ds_read_b128 v[120:123], v134 offset:24576
ds_read_b128 v[124:127], v135 offset:24576
s_waitcnt lgkmcnt(7)
v_dot2c_f32_bf16 v136, s60, v96
v_dot2c_f32_bf16 v138, v96, v96
v_dot2c_f32_bf16 v137, s60, v97
v_dot2c_f32_bf16 v139, v97, v97
v_dot2c_f32_bf16 v136, s60, v98
v_dot2c_f32_bf16 v138, v98, v98
v_dot2c_f32_bf16 v137, s60, v99
v_dot2c_f32_bf16 v139, v99, v99
s_waitcnt lgkmcnt(6)
v_dot2c_f32_bf16 v136, s60, v100
v_dot2c_f32_bf16 v138, v100, v100
v_dot2c_f32_bf16 v137, s60, v101
v_dot2c_f32_bf16 v139, v101, v101
v_dot2c_f32_bf16 v136, s60, v102
v_dot2c_f32_bf16 v138, v102, v102
v_dot2c_f32_bf16 v137, s60, v103
v_dot2c_f32_bf16 v139, v103, v103
s_waitcnt lgkmcnt(5)
v_dot2c_f32_bf16 v136, s60, v104
v_dot2c_f32_bf16 v138, v104, v104
v_dot2c_f32_bf16 v137, s60, v105
v_dot2c_f32_bf16 v139, v105, v105
v_dot2c_f32_bf16 v136, s60, v106
v_dot2c_f32_bf16 v138, v106, v106
v_dot2c_f32_bf16 v137, s60, v107
v_dot2c_f32_bf16 v139, v107, v107
s_waitcnt lgkmcnt(4)
v_dot2c_f32_bf16 v136, s60, v108
v_dot2c_f32_bf16 v138, v108, v108
v_dot2c_f32_bf16 v137, s60, v109
v_dot2c_f32_bf16 v139, v109, v109
v_dot2c_f32_bf16 v136, s60, v110
v_dot2c_f32_bf16 v138, v110, v110
v_dot2c_f32_bf16 v137, s60, v111
v_dot2c_f32_bf16 v139, v111, v111
s_waitcnt lgkmcnt(3)
v_dot2c_f32_bf16 v136, s60, v112
v_dot2c_f32_bf16 v138, v112, v112
v_dot2c_f32_bf16 v137, s60, v113
v_dot2c_f32_bf16 v139, v113, v113
v_dot2c_f32_bf16 v136, s60, v114
v_dot2c_f32_bf16 v138, v114, v114
v_dot2c_f32_bf16 v137, s60, v115
v_dot2c_f32_bf16 v139, v115, v115
s_waitcnt lgkmcnt(2)
v_dot2c_f32_bf16 v136, s60, v116
v_dot2c_f32_bf16 v138, v116, v116
v_dot2c_f32_bf16 v137, s60, v117
v_dot2c_f32_bf16 v139, v117, v117
v_dot2c_f32_bf16 v136, s60, v118
v_dot2c_f32_bf16 v138, v118, v118
v_dot2c_f32_bf16 v137, s60, v119
v_dot2c_f32_bf16 v139, v119, v119
s_waitcnt lgkmcnt(1)
v_dot2c_f32_bf16 v136, s60, v120
v_dot2c_f32_bf16 v138, v120, v120
v_dot2c_f32_bf16 v137, s60, v121
v_dot2c_f32_bf16 v139, v121, v121
v_dot2c_f32_bf16 v136, s60, v122
v_dot2c_f32_bf16 v138, v122, v122
v_dot2c_f32_bf16 v137, s60, v123
v_dot2c_f32_bf16 v139, v123, v123
s_waitcnt lgkmcnt(0)
v_dot2c_f32_bf16 v136, s60, v124
v_dot2c_f32_bf16 v138, v124, v124
v_dot2c_f32_bf16 v137, s60, v125
v_dot2c_f32_bf16 v139, v125, v125
v_dot2c_f32_bf16 v136, s60, v126
v_dot2c_f32_bf16 v138, v126, v126
v_dot2c_f32_bf16 v137, s60, v127
v_dot2c_f32_bf16 v139, v127, v127
s_nop 1
v_add_f32 v136, v136, v137
v_add_f32 v138, v138, v139
v_mov_b32 v137, v136
v_mov_b32 v139, v138
s_nop 0
v_permlane32_swap_b32 v136, v137
v_permlane32_swap_b32 v138, v139
v_add_f32 v136, v136, v137
v_add_f32 v138, v138, v139
v_mul_f32 v9, 0xbb124925, v136
v_mul_f32 v138, 0x3b124925, v138
v_fma_f32 v138, -v9, v9, v138
v_max_f32 v138, 0, v138
v_add_f32 v138, 0x3727c5ac, v138
v_rsq_f32 v10, v138
v_mov_b32 v12, s60
v_mul_f32 v9, v9, v10
s_waitcnt vmcnt(4)
s_barrier
ds_read_b64_tr_b16 a[224:225], v248 offset:0
ds_read_b64_tr_b16 a[226:227], v248 offset:512
ds_read_b64_tr_b16 a[228:229], v249 offset:0
ds_read_b64_tr_b16 a[230:231], v249 offset:512
ds_read_b64_tr_b16 a[232:233], v248 offset:2080
ds_read_b64_tr_b16 a[234:235], v248 offset:2592
ds_read_b64_tr_b16 a[236:237], v248 offset:4128
ds_read_b64_tr_b16 a[238:239], v248 offset:4640
ds_read_b64_tr_b16 a[240:241], v249 offset:4128
ds_read_b64_tr_b16 a[242:243], v249 offset:4640
ds_read_b64_tr_b16 a[244:245], v248 offset:6208
ds_read_b64_tr_b16 a[246:247], v248 offset:6720
v_lshlrev_b32 v240, 16, v16
v_and_b32 v241, 0xffff0000, v16
v_lshlrev_b32 v242, 16, v17
v_and_b32 v243, 0xffff0000, v17
v_lshlrev_b32 v244, 16, v18
v_and_b32 v245, 0xffff0000, v18
v_fma_f32 v240, v240, v10, v9
v_fma_f32 v241, v241, v10, v9
v_cvt_pk_bf16_f32 v16, v240, v241
v_lshlrev_b32 v246, 16, v19
v_and_b32 v247, 0xffff0000, v19
v_fma_f32 v242, v242, v10, v9
v_fma_f32 v243, v243, v10, v9
v_cvt_pk_bf16_f32 v17, v242, v243
v_lshlrev_b32 v240, 16, v20
v_and_b32 v241, 0xffff0000, v20
v_fma_f32 v244, v244, v10, v9
v_fma_f32 v245, v245, v10, v9
v_cvt_pk_bf16_f32 v18, v244, v245
v_lshlrev_b32 v242, 16, v21
v_and_b32 v243, 0xffff0000, v21
v_fma_f32 v246, v246, v10, v9
v_fma_f32 v247, v247, v10, v9
v_cvt_pk_bf16_f32 v19, v246, v247
s_waitcnt lgkmcnt(8)
s_nop 0
v_mfma_f32_32x32x16_bf16 v[192:207], a[224:227], v[16:19], 0
s_add_u32 m0, s43, 33024
ds_read_b64_tr_b16 a[248:249], v248 offset:8256
ds_read_b64_tr_b16 a[250:251], v248 offset:8768
buffer_load_dwordx4 v8, s[12:15], s46 offen lds
s_add_u32 s46, s46, 43008
v_lshlrev_b32 v244, 16, v22
v_and_b32 v245, 0xffff0000, v22
v_fma_f32 v240, v240, v10, v9
v_fma_f32 v241, v241, v10, v9
v_cvt_pk_bf16_f32 v20, v240, v241
v_lshlrev_b32 v246, 16, v23
v_and_b32 v247, 0xffff0000, v23
v_mfma_f32_32x32x16_bf16 v[208:223], a[228:231], v[16:19], 0
s_add_u32 m0, s43, 37152
s_waitcnt lgkmcnt(6)
ds_read_b64_tr_b16 a[252:253], v249 offset:8256
ds_read_b64_tr_b16 a[254:255], v249 offset:8768
buffer_load_dwordx4 v8, s[12:15], s46 offen lds
s_add_u32 s46, s46, 43008
v_fma_f32 v242, v242, v10, v9
v_fma_f32 v243, v243, v10, v9
v_cvt_pk_bf16_f32 v21, v242, v243
v_lshlrev_b32 v240, 16, v24
v_and_b32 v241, 0xffff0000, v24
v_fma_f32 v244, v244, v10, v9
v_fma_f32 v245, v245, v10, v9
v_mfma_f32_32x32x16_bf16 v[224:239], v[16:19], a[232:235], 0
ds_read_b64_tr_b16 a[224:225], v248 offset:10336
ds_read_b64_tr_b16 a[226:227], v248 offset:10848
v_cvt_pk_bf16_f32 v22, v244, v245
v_lshlrev_b32 v242, 16, v25
v_and_b32 v243, 0xffff0000, v25
v_fma_f32 v246, v246, v10, v9
v_fma_f32 v247, v247, v10, v9
v_cvt_pk_bf16_f32 v23, v246, v247
s_nop 1
v_mfma_f32_32x32x16_bf16 v[192:207], a[236:239], v[20:23], v[192:207]
s_add_u32 m0, s43, 41280
s_waitcnt lgkmcnt(6)
ds_read_b64_tr_b16 a[228:229], v248 offset:12384
ds_read_b64_tr_b16 a[230:231], v248 offset:12896
buffer_load_dwordx4 v8, s[12:15], s46 offen lds
s_add_u32 s46, s46, 43008
v_lshlrev_b32 v244, 16, v26
v_and_b32 v245, 0xffff0000, v26
v_fma_f32 v240, v240, v10, v9
v_fma_f32 v241, v241, v10, v9
v_cvt_pk_bf16_f32 v24, v240, v241
v_lshlrev_b32 v246, 16, v27
v_and_b32 v247, 0xffff0000, v27
v_mfma_f32_32x32x16_bf16 v[208:223], a[240:243], v[20:23], v[208:223]
s_add_u32 m0, s43, 45408
ds_read_b64_tr_b16 a[232:233], v249 offset:12384
ds_read_b64_tr_b16 a[234:235], v249 offset:12896
buffer_load_dwordx4 v8, s[12:15], s46 offen lds
s_add_u32 s46, s46, 43008
s_sub_u32 s3, s46, 1204224
s_cmp_eq_u32 s3, s0
s_cselect_b32 s46, s0, s46
v_fma_f32 v242, v242, v10, v9
v_fma_f32 v243, v243, v10, v9
v_cvt_pk_bf16_f32 v25, v242, v243
v_lshlrev_b32 v240, 16, v28
v_and_b32 v241, 0xffff0000, v28
v_fma_f32 v244, v244, v10, v9
v_fma_f32 v245, v245, v10, v9
v_mfma_f32_32x32x16_bf16 v[224:239], v[20:23], a[244:247], v[224:239]
s_waitcnt lgkmcnt(6)
ds_read_b64_tr_b16 a[236:237], v248 offset:14464
ds_read_b64_tr_b16 a[238:239], v248 offset:14976
v_cvt_pk_bf16_f32 v26, v244, v245
v_lshlrev_b32 v242, 16, v29
v_and_b32 v243, 0xffff0000, v29
v_fma_f32 v246, v246, v10, v9
v_fma_f32 v247, v247, v10, v9
v_cvt_pk_bf16_f32 v27, v246, v247
s_mov_b32 m0, s63
s_nop 0
buffer_load_dwordx4 v150, s[20:23], 0 offen lds
v_mfma_f32_32x32x16_bf16 v[192:207], a[248:251], v[24:27], v[192:207]
s_add_u32 m0, s43, 49536
s_waitcnt vmcnt(5)
s_barrier
ds_read_b64_tr_b16 a[240:241], v248 offset:16512
ds_read_b64_tr_b16 a[242:243], v248 offset:17024
buffer_load_dwordx4 v8, s[12:15], s46 offen lds
s_add_u32 s46, s46, 43008
v_lshlrev_b32 v244, 16, v30
v_and_b32 v245, 0xffff0000, v30
v_fma_f32 v240, v240, v10, v9
v_fma_f32 v241, v241, v10, v9
v_cvt_pk_bf16_f32 v28, v240, v241
v_lshlrev_b32 v246, 16, v31
v_and_b32 v247, 0xffff0000, v31
v_mfma_f32_32x32x16_bf16 v[208:223], a[252:255], v[24:27], v[208:223]
s_add_u32 m0, s43, 53664
s_waitcnt lgkmcnt(6)
ds_read_b64_tr_b16 a[244:245], v249 offset:16512
ds_read_b64_tr_b16 a[246:247], v249 offset:17024
buffer_load_dwordx4 v8, s[12:15], s46 offen lds
s_add_u32 s46, s46, 43008
v_fma_f32 v242, v242, v10, v9
v_fma_f32 v243, v243, v10, v9
v_cvt_pk_bf16_f32 v29, v242, v243
v_lshlrev_b32 v240, 16, v32
v_and_b32 v241, 0xffff0000, v32
v_fma_f32 v244, v244, v10, v9
v_fma_f32 v245, v245, v10, v9
v_mfma_f32_32x32x16_bf16 v[224:239], v[24:27], a[224:227], v[224:239]
ds_read_b64_tr_b16 a[248:249], v248 offset:18592
ds_read_b64_tr_b16 a[250:251], v248 offset:19104
v_cvt_pk_bf16_f32 v30, v244, v245
v_lshlrev_b32 v242, 16, v33
v_and_b32 v243, 0xffff0000, v33
v_fma_f32 v246, v246, v10, v9
v_fma_f32 v247, v247, v10, v9
v_cvt_pk_bf16_f32 v31, v246, v247
s_add_u32 m0, s63, 1024
s_nop 0
buffer_load_dwordx4 v151, s[20:23], 0 offen lds
v_mfma_f32_32x32x16_bf16 v[192:207], a[228:231], v[28:31], v[192:207]
s_add_u32 m0, s43, 57792
s_waitcnt lgkmcnt(6)
ds_read_b64_tr_b16 a[252:253], v248 offset:20640
ds_read_b64_tr_b16 a[254:255], v248 offset:21152
buffer_load_dwordx4 v8, s[12:15], s46 offen lds
s_add_u32 s46, s46, 43008
v_lshlrev_b32 v244, 16, v34
v_and_b32 v245, 0xffff0000, v34
v_fma_f32 v240, v240, v10, v9
v_fma_f32 v241, v241, v10, v9
v_cvt_pk_bf16_f32 v32, v240, v241
v_lshlrev_b32 v246, 16, v35
v_and_b32 v247, 0xffff0000, v35
v_mfma_f32_32x32x16_bf16 v[208:223], a[232:235], v[28:31], v[208:223]
s_add_u32 m0, s43, 61920
ds_read_b64_tr_b16 a[224:225], v249 offset:20640
ds_read_b64_tr_b16 a[226:227], v249 offset:21152
buffer_load_dwordx4 v8, s[12:15], s46 offen lds
s_add_u32 s46, s46, 43008
s_sub_u32 s3, s46, 1204224
s_cmp_eq_u32 s3, s0
s_cselect_b32 s46, s0, s46
v_fma_f32 v242, v242, v10, v9
v_fma_f32 v243, v243, v10, v9
v_cvt_pk_bf16_f32 v33, v242, v243
v_lshlrev_b32 v240, 16, v36
v_and_b32 v241, 0xffff0000, v36
v_fma_f32 v244, v244, v10, v9
v_fma_f32 v245, v245, v10, v9
v_mfma_f32_32x32x16_bf16 v[224:239], v[28:31], a[236:239], v[224:239]
s_waitcnt lgkmcnt(6)
ds_read_b64_tr_b16 a[228:229], v248 offset:22720
ds_read_b64_tr_b16 a[230:231], v248 offset:23232
v_cvt_pk_bf16_f32 v34, v244, v245
v_lshlrev_b32 v242, 16, v37
v_and_b32 v243, 0xffff0000, v37
v_fma_f32 v246, v246, v10, v9
v_fma_f32 v247, v247, v10, v9
v_cvt_pk_bf16_f32 v35, v246, v247
s_nop 1
v_mfma_f32_32x32x16_bf16 v[192:207], a[240:243], v[32:35], v[192:207]
s_add_u32 m0, s43, 66048
ds_read_b64_tr_b16 a[232:233], v248 offset:24768
ds_read_b64_tr_b16 a[234:235], v248 offset:25280
buffer_load_dwordx4 v8, s[12:15], s46 offen lds
s_add_u32 s46, s46, 43008
v_lshlrev_b32 v244, 16, v38
v_and_b32 v245, 0xffff0000, v38
v_fma_f32 v240, v240, v10, v9
v_fma_f32 v241, v241, v10, v9
v_cvt_pk_bf16_f32 v36, v240, v241
v_lshlrev_b32 v246, 16, v39
v_and_b32 v247, 0xffff0000, v39
v_mfma_f32_32x32x16_bf16 v[208:223], a[244:247], v[32:35], v[208:223]
s_add_u32 m0, s43, 70176
s_waitcnt lgkmcnt(6)
ds_read_b64_tr_b16 a[236:237], v249 offset:24768
ds_read_b64_tr_b16 a[238:239], v249 offset:25280
buffer_load_dwordx4 v8, s[12:15], s46 offen lds
s_add_u32 s46, s46, 43008
v_fma_f32 v242, v242, v10, v9
v_fma_f32 v243, v243, v10, v9
v_cvt_pk_bf16_f32 v37, v242, v243
v_lshlrev_b32 v240, 16, v40
v_and_b32 v241, 0xffff0000, v40
v_fma_f32 v244, v244, v10, v9
v_fma_f32 v245, v245, v10, v9
v_mfma_f32_32x32x16_bf16 v[224:239], v[32:35], a[248:251], v[224:239]
ds_read_b64_tr_b16 a[240:241], v248 offset:26848
ds_read_b64_tr_b16 a[242:243], v248 offset:27360
v_cvt_pk_bf16_f32 v38, v244, v245
v_lshlrev_b32 v242, 16, v41
v_and_b32 v243, 0xffff0000, v41
v_fma_f32 v246, v246, v10, v9
v_fma_f32 v247, v247, v10, v9
v_cvt_pk_bf16_f32 v39, v246, v247
s_nop 1
v_mfma_f32_32x32x16_bf16 v[192:207], a[252:255], v[36:39], v[192:207]
s_add_u32 m0, s43, 74304
s_waitcnt lgkmcnt(6)
ds_read_b64_tr_b16 a[244:245], v248 offset:28896
ds_read_b64_tr_b16 a[246:247], v248 offset:29408
buffer_load_dwordx4 v8, s[12:15], s46 offen lds
s_add_u32 s46, s46, 43008
v_lshlrev_b32 v244, 16, v42
v_and_b32 v245, 0xffff0000, v42
v_fma_f32 v240, v240, v10, v9
v_fma_f32 v241, v241, v10, v9
v_cvt_pk_bf16_f32 v40, v240, v241
v_lshlrev_b32 v246, 16, v43
v_and_b32 v247, 0xffff0000, v43
v_mfma_f32_32x32x16_bf16 v[208:223], a[224:227], v[36:39], v[208:223]
s_add_u32 m0, s43, 78432
ds_read_b64_tr_b16 a[248:249], v249 offset:28896
ds_read_b64_tr_b16 a[250:251], v249 offset:29408
buffer_load_dwordx4 v8, s[12:15], s46 offen lds
s_add_u32 s46, s46, 43008
s_sub_u32 s3, s46, 1204224
s_cmp_eq_u32 s3, s0
s_cselect_b32 s46, s0, s46
v_fma_f32 v242, v242, v10, v9
v_fma_f32 v243, v243, v10, v9
v_cvt_pk_bf16_f32 v41, v242, v243
v_lshlrev_b32 v240, 16, v44
v_and_b32 v241, 0xffff0000, v44
v_fma_f32 v244, v244, v10, v9
v_fma_f32 v245, v245, v10, v9
v_mfma_f32_32x32x16_bf16 v[224:239], v[36:39], a[228:231], v[224:239]
s_waitcnt lgkmcnt(6)
ds_read_b64_tr_b16 a[252:253], v248 offset:30976
ds_read_b64_tr_b16 a[254:255], v248 offset:31488
v_cvt_pk_bf16_f32 v42, v244, v245
v_lshlrev_b32 v242, 16, v45
v_and_b32 v243, 0xffff0000, v45
v_fma_f32 v246, v246, v10, v9
v_fma_f32 v247, v247, v10, v9
v_cvt_pk_bf16_f32 v43, v246, v247
s_nop 1
v_mfma_f32_32x32x16_bf16 v[192:207], a[232:235], v[40:43], v[192:207]
s_add_u32 m0, s43, 82560
s_waitcnt vmcnt(10)
s_barrier
ds_read_b64_tr_b16 a[224:225], v248 offset:33024
ds_read_b64_tr_b16 a[226:227], v248 offset:33536
buffer_load_dwordx4 v8, s[12:15], s46 offen lds
s_add_u32 s46, s46, 43008
v_lshlrev_b32 v244, 16, v46
v_and_b32 v245, 0xffff0000, v46
v_fma_f32 v240, v240, v10, v9
v_fma_f32 v241, v241, v10, v9
v_cvt_pk_bf16_f32 v44, v240, v241
v_lshlrev_b32 v246, 16, v47
v_and_b32 v247, 0xffff0000, v47
v_mfma_f32_32x32x16_bf16 v[208:223], a[236:239], v[40:43], v[208:223]
s_add_u32 m0, s43, 86688
s_waitcnt lgkmcnt(6)
ds_read_b64_tr_b16 a[228:229], v249 offset:33024
ds_read_b64_tr_b16 a[230:231], v249 offset:33536
buffer_load_dwordx4 v8, s[12:15], s46 offen lds
s_add_u32 s46, s46, 43008
v_fma_f32 v242, v242, v10, v9
v_fma_f32 v243, v243, v10, v9
v_cvt_pk_bf16_f32 v45, v242, v243
v_lshlrev_b32 v240, 16, v48
v_and_b32 v241, 0xffff0000, v48
v_fma_f32 v244, v244, v10, v9
v_fma_f32 v245, v245, v10, v9
v_mfma_f32_32x32x16_bf16 v[224:239], v[40:43], a[240:243], v[224:239]
ds_read_b64_tr_b16 a[232:233], v248 offset:35104
ds_read_b64_tr_b16 a[234:235], v248 offset:35616
v_cvt_pk_bf16_f32 v46, v244, v245
v_lshlrev_b32 v242, 16, v49
v_and_b32 v243, 0xffff0000, v49
v_fma_f32 v246, v246, v10, v9
v_fma_f32 v247, v247, v10, v9
v_cvt_pk_bf16_f32 v47, v246, v247
s_nop 1
v_mfma_f32_32x32x16_bf16 v[192:207], a[244:247], v[44:47], v[192:207]
s_add_u32 m0, s43, 90816
s_waitcnt lgkmcnt(6)
ds_read_b64_tr_b16 a[236:237], v248 offset:37152
ds_read_b64_tr_b16 a[238:239], v248 offset:37664
buffer_load_dwordx4 v8, s[12:15], s46 offen lds
s_add_u32 s46, s46, 43008
v_lshlrev_b32 v244, 16, v50
v_and_b32 v245, 0xffff0000, v50
v_fma_f32 v240, v240, v10, v9
v_fma_f32 v241, v241, v10, v9
v_cvt_pk_bf16_f32 v48, v240, v241
v_lshlrev_b32 v246, 16, v51
v_and_b32 v247, 0xffff0000, v51
v_mfma_f32_32x32x16_bf16 v[208:223], a[248:251], v[44:47], v[208:223]
s_add_u32 m0, s43, 94944
ds_read_b64_tr_b16 a[240:241], v249 offset:37152
ds_read_b64_tr_b16 a[242:243], v249 offset:37664
buffer_load_dwordx4 v8, s[12:15], s46 offen lds
s_add_u32 s46, s46, 43008
s_sub_u32 s3, s46, 1204224
s_cmp_eq_u32 s3, s0
s_cselect_b32 s46, s0, s46
v_fma_f32 v242, v242, v10, v9
v_fma_f32 v243, v243, v10, v9
v_cvt_pk_bf16_f32 v49, v242, v243
v_lshlrev_b32 v240, 16, v52
v_and_b32 v241, 0xffff0000, v52
v_fma_f32 v244, v244, v10, v9
v_fma_f32 v245, v245, v10, v9
v_mfma_f32_32x32x16_bf16 v[224:239], v[44:47], a[252:255], v[224:239]
s_waitcnt lgkmcnt(6)
ds_read_b64_tr_b16 a[244:245], v248 offset:39232
ds_read_b64_tr_b16 a[246:247], v248 offset:39744
v_cvt_pk_bf16_f32 v50, v244, v245
v_lshlrev_b32 v242, 16, v53
v_and_b32 v243, 0xffff0000, v53
v_fma_f32 v246, v246, v10, v9
v_fma_f32 v247, v247, v10, v9
v_cvt_pk_bf16_f32 v51, v246, v247
s_nop 1
v_mfma_f32_32x32x16_bf16 v[192:207], a[224:227], v[48:51], v[192:207]
s_add_u32 m0, s43, 99072
ds_read_b64_tr_b16 a[248:249], v248 offset:41280
ds_read_b64_tr_b16 a[250:251], v248 offset:41792
buffer_load_dwordx4 v8, s[12:15], s46 offen lds
s_add_u32 s46, s46, 43008
v_lshlrev_b32 v244, 16, v54
v_and_b32 v245, 0xffff0000, v54
v_fma_f32 v240, v240, v10, v9
v_fma_f32 v241, v241, v10, v9
v_cvt_pk_bf16_f32 v52, v240, v241
v_lshlrev_b32 v246, 16, v55
v_and_b32 v247, 0xffff0000, v55
v_mfma_f32_32x32x16_bf16 v[208:223], a[228:231], v[48:51], v[208:223]
s_waitcnt lgkmcnt(6)
ds_read_b64_tr_b16 a[252:253], v249 offset:41280
ds_read_b64_tr_b16 a[254:255], v249 offset:41792
v_fma_f32 v242, v242, v10, v9
v_fma_f32 v243, v243, v10, v9
v_cvt_pk_bf16_f32 v53, v242, v243
v_lshlrev_b32 v240, 16, v56
v_and_b32 v241, 0xffff0000, v56
v_fma_f32 v244, v244, v10, v9
v_fma_f32 v245, v245, v10, v9
v_mfma_f32_32x32x16_bf16 v[224:239], v[48:51], a[232:235], v[224:239]
ds_read_b64_tr_b16 a[224:225], v248 offset:43360
ds_read_b64_tr_b16 a[226:227], v248 offset:43872
v_cvt_pk_bf16_f32 v54, v244, v245
v_lshlrev_b32 v242, 16, v57
v_and_b32 v243, 0xffff0000, v57
v_fma_f32 v246, v246, v10, v9
v_fma_f32 v247, v247, v10, v9
v_cvt_pk_bf16_f32 v55, v246, v247
s_nop 1
v_mfma_f32_32x32x16_bf16 v[192:207], a[236:239], v[52:55], v[192:207]
s_add_u32 m0, s43, 103200
s_waitcnt lgkmcnt(6)
ds_read_b64_tr_b16 a[228:229], v248 offset:45408
ds_read_b64_tr_b16 a[230:231], v248 offset:45920
buffer_load_dwordx4 v8, s[12:15], s46 offen lds
s_add_u32 s46, s46, 43008
v_lshlrev_b32 v244, 16, v58
v_and_b32 v245, 0xffff0000, v58
v_fma_f32 v240, v240, v10, v9
v_fma_f32 v241, v241, v10, v9
v_cvt_pk_bf16_f32 v56, v240, v241
v_lshlrev_b32 v246, 16, v59
v_and_b32 v247, 0xffff0000, v59
v_mfma_f32_32x32x16_bf16 v[208:223], a[240:243], v[52:55], v[208:223]
ds_read_b64_tr_b16 a[232:233], v249 offset:45408
ds_read_b64_tr_b16 a[234:235], v249 offset:45920
v_fma_f32 v242, v242, v10, v9
v_fma_f32 v243, v243, v10, v9
v_cvt_pk_bf16_f32 v57, v242, v243
v_lshlrev_b32 v240, 16, v60
v_and_b32 v241, 0xffff0000, v60
v_fma_f32 v244, v244, v10, v9
v_fma_f32 v245, v245, v10, v9
v_mfma_f32_32x32x16_bf16 v[224:239], v[52:55], a[244:247], v[224:239]
s_waitcnt lgkmcnt(6)
ds_read_b64_tr_b16 a[236:237], v248 offset:47488
ds_read_b64_tr_b16 a[238:239], v248 offset:48000
v_cvt_pk_bf16_f32 v58, v244, v245
v_lshlrev_b32 v242, 16, v61
v_and_b32 v243, 0xffff0000, v61
v_fma_f32 v246, v246, v10, v9
v_fma_f32 v247, v247, v10, v9
v_cvt_pk_bf16_f32 v59, v246, v247
s_nop 1
v_mfma_f32_32x32x16_bf16 v[192:207], a[248:251], v[56:59], v[192:207]
s_add_u32 m0, s43, 107328
s_waitcnt vmcnt(10)
s_barrier
ds_read_b64_tr_b16 a[240:241], v248 offset:49536
ds_read_b64_tr_b16 a[242:243], v248 offset:50048
buffer_load_dwordx4 v8, s[12:15], s46 offen lds
s_add_u32 s46, s46, 43008
v_lshlrev_b32 v244, 16, v62
v_and_b32 v245, 0xffff0000, v62
v_fma_f32 v240, v240, v10, v9
v_fma_f32 v241, v241, v10, v9
v_cvt_pk_bf16_f32 v60, v240, v241
v_lshlrev_b32 v246, 16, v63
v_and_b32 v247, 0xffff0000, v63
v_mfma_f32_32x32x16_bf16 v[208:223], a[252:255], v[56:59], v[208:223]
s_waitcnt lgkmcnt(6)
ds_read_b64_tr_b16 a[244:245], v249 offset:49536
ds_read_b64_tr_b16 a[246:247], v249 offset:50048
v_fma_f32 v242, v242, v10, v9
v_fma_f32 v243, v243, v10, v9
v_cvt_pk_bf16_f32 v61, v242, v243
v_lshlrev_b32 v240, 16, v64
v_and_b32 v241, 0xffff0000, v64
v_fma_f32 v244, v244, v10, v9
v_fma_f32 v245, v245, v10, v9
v_mfma_f32_32x32x16_bf16 v[224:239], v[56:59], a[224:227], v[224:239]
ds_read_b64_tr_b16 a[248:249], v248 offset:51616
ds_read_b64_tr_b16 a[250:251], v248 offset:52128
v_cvt_pk_bf16_f32 v62, v244, v245
v_lshlrev_b32 v242, 16, v65
v_and_b32 v243, 0xffff0000, v65
v_fma_f32 v246, v246, v10, v9
v_fma_f32 v247, v247, v10, v9
v_cvt_pk_bf16_f32 v63, v246, v247
s_nop 1
v_mfma_f32_32x32x16_bf16 v[192:207], a[228:231], v[60:63], v[192:207]
s_add_u32 m0, s43, 111456
s_waitcnt lgkmcnt(6)
ds_read_b64_tr_b16 a[252:253], v248 offset:53664
ds_read_b64_tr_b16 a[254:255], v248 offset:54176
buffer_load_dwordx4 v8, s[12:15], s46 offen lds
s_add_u32 s46, s47, s1
s_mov_b32 s0, s61
v_lshlrev_b32 v244, 16, v66
v_and_b32 v245, 0xffff0000, v66
v_fma_f32 v240, v240, v10, v9
v_fma_f32 v241, v241, v10, v9
v_cvt_pk_bf16_f32 v64, v240, v241
v_lshlrev_b32 v246, 16, v67
v_and_b32 v247, 0xffff0000, v67
v_mfma_f32_32x32x16_bf16 v[208:223], a[232:235], v[60:63], v[208:223]
ds_read_b64_tr_b16 a[224:225], v249 offset:53664
ds_read_b64_tr_b16 a[226:227], v249 offset:54176
v_fma_f32 v242, v242, v10, v9
v_fma_f32 v243, v243, v10, v9
v_cvt_pk_bf16_f32 v65, v242, v243
v_lshlrev_b32 v240, 16, v68
v_and_b32 v241, 0xffff0000, v68
v_fma_f32 v244, v244, v10, v9
v_fma_f32 v245, v245, v10, v9
v_mfma_f32_32x32x16_bf16 v[224:239], v[60:63], a[236:239], v[224:239]
s_waitcnt lgkmcnt(6)
ds_read_b64_tr_b16 a[228:229], v248 offset:55744
ds_read_b64_tr_b16 a[230:231], v248 offset:56256
v_cvt_pk_bf16_f32 v66, v244, v245
v_lshlrev_b32 v242, 16, v69
v_and_b32 v243, 0xffff0000, v69
v_fma_f32 v246, v246, v10, v9
v_fma_f32 v247, v247, v10, v9
v_cvt_pk_bf16_f32 v67, v246, v247
s_nop 1
v_mfma_f32_32x32x16_bf16 v[192:207], a[240:243], v[64:67], v[192:207]
s_add_u32 m0, s43, 115584
ds_read_b64_tr_b16 a[232:233], v248 offset:57792
ds_read_b64_tr_b16 a[234:235], v248 offset:58304
buffer_load_dwordx4 v7, s[8:11], s46 offen lds
s_add_u32 s46, s46, 57344
v_lshlrev_b32 v244, 16, v70
v_and_b32 v245, 0xffff0000, v70
v_fma_f32 v240, v240, v10, v9
v_fma_f32 v241, v241, v10, v9
v_cvt_pk_bf16_f32 v68, v240, v241
v_lshlrev_b32 v246, 16, v71
v_and_b32 v247, 0xffff0000, v71
v_mfma_f32_32x32x16_bf16 v[208:223], a[244:247], v[64:67], v[208:223]
s_waitcnt lgkmcnt(6)
ds_read_b64_tr_b16 a[236:237], v249 offset:57792
ds_read_b64_tr_b16 a[238:239], v249 offset:58304
v_fma_f32 v242, v242, v10, v9
v_fma_f32 v243, v243, v10, v9
v_cvt_pk_bf16_f32 v69, v242, v243
v_lshlrev_b32 v240, 16, v72
v_and_b32 v241, 0xffff0000, v72
v_fma_f32 v244, v244, v10, v9
v_fma_f32 v245, v245, v10, v9
v_mfma_f32_32x32x16_bf16 v[224:239], v[64:67], a[248:251], v[224:239]
ds_read_b64_tr_b16 a[240:241], v248 offset:59872
ds_read_b64_tr_b16 a[242:243], v248 offset:60384
v_cvt_pk_bf16_f32 v70, v244, v245
v_lshlrev_b32 v242, 16, v73
v_and_b32 v243, 0xffff0000, v73
v_fma_f32 v246, v246, v10, v9
v_fma_f32 v247, v247, v10, v9
v_cvt_pk_bf16_f32 v71, v246, v247
s_nop 1
v_mfma_f32_32x32x16_bf16 v[192:207], a[252:255], v[68:71], v[192:207]
s_add_u32 m0, s43, 119712
s_waitcnt lgkmcnt(6)
ds_read_b64_tr_b16 a[244:245], v250 offset:0
ds_read_b64_tr_b16 a[246:247], v250 offset:512
buffer_load_dwordx4 v7, s[8:11], s46 offen lds
s_add_u32 s46, s46, 57344
v_lshlrev_b32 v244, 16, v74
v_and_b32 v245, 0xffff0000, v74
v_fma_f32 v240, v240, v10, v9
v_fma_f32 v241, v241, v10, v9
v_cvt_pk_bf16_f32 v72, v240, v241
v_lshlrev_b32 v246, 16, v75
v_and_b32 v247, 0xffff0000, v75
v_mfma_f32_32x32x16_bf16 v[208:223], a[224:227], v[68:71], v[208:223]
ds_read_b64_tr_b16 a[248:249], v251 offset:0
ds_read_b64_tr_b16 a[250:251], v251 offset:512
v_fma_f32 v242, v242, v10, v9
v_fma_f32 v243, v243, v10, v9
v_cvt_pk_bf16_f32 v73, v242, v243
v_lshlrev_b32 v240, 16, v76
v_and_b32 v241, 0xffff0000, v76
v_fma_f32 v244, v244, v10, v9
v_fma_f32 v245, v245, v10, v9
v_mfma_f32_32x32x16_bf16 v[224:239], v[68:71], a[228:231], v[224:239]
s_waitcnt lgkmcnt(6)
ds_read_b64_tr_b16 a[252:253], v250 offset:2080
ds_read_b64_tr_b16 a[254:255], v250 offset:2592
v_cvt_pk_bf16_f32 v74, v244, v245
v_lshlrev_b32 v242, 16, v77
v_and_b32 v243, 0xffff0000, v77
v_fma_f32 v246, v246, v10, v9
v_fma_f32 v247, v247, v10, v9
v_cvt_pk_bf16_f32 v75, v246, v247
s_nop 1
v_mfma_f32_32x32x16_bf16 v[192:207], a[232:235], v[72:75], v[192:207]
s_add_u32 m0, s43, 123840
s_waitcnt vmcnt(10)
s_barrier
ds_read_b64_tr_b16 a[224:225], v250 offset:4128
ds_read_b64_tr_b16 a[226:227], v250 offset:4640
buffer_load_dwordx4 v7, s[8:11], s46 offen lds
s_add_u32 s46, s46, 57344
v_lshlrev_b32 v244, 16, v78
v_and_b32 v245, 0xffff0000, v78
v_fma_f32 v240, v240, v10, v9
v_fma_f32 v241, v241, v10, v9
v_cvt_pk_bf16_f32 v76, v240, v241
v_lshlrev_b32 v246, 16, v79
v_and_b32 v247, 0xffff0000, v79
v_mfma_f32_32x32x16_bf16 v[208:223], a[236:239], v[72:75], v[208:223]
s_waitcnt lgkmcnt(6)
ds_read_b64_tr_b16 a[228:229], v251 offset:4128
ds_read_b64_tr_b16 a[230:231], v251 offset:4640
v_fma_f32 v242, v242, v10, v9
v_fma_f32 v243, v243, v10, v9
v_cvt_pk_bf16_f32 v77, v242, v243
v_lshlrev_b32 v240, 16, v80
v_and_b32 v241, 0xffff0000, v80
v_fma_f32 v244, v244, v10, v9
v_fma_f32 v245, v245, v10, v9
v_mfma_f32_32x32x16_bf16 v[224:239], v[72:75], a[240:243], v[224:239]
ds_read_b64_tr_b16 a[232:233], v250 offset:6208
ds_read_b64_tr_b16 a[234:235], v250 offset:6720
v_cvt_pk_bf16_f32 v78, v244, v245
v_lshlrev_b32 v242, 16, v81
v_and_b32 v243, 0xffff0000, v81
v_fma_f32 v246, v246, v10, v9
v_fma_f32 v247, v247, v10, v9
v_cvt_pk_bf16_f32 v79, v246, v247
s_nop 1
v_mfma_f32_32x32x16_bf16 v[192:207], a[244:247], v[76:79], v[192:207]
s_add_u32 m0, s43, 127968
s_waitcnt lgkmcnt(6)
ds_read_b64_tr_b16 a[236:237], v250 offset:8256
ds_read_b64_tr_b16 a[238:239], v250 offset:8768
buffer_load_dwordx4 v7, s[8:11], s46 offen lds
s_add_u32 s46, s46, 57344
s_sub_u32 s3, s46, 1605632
s_cmp_eq_u32 s3, s47
s_cselect_b32 s46, s47, s46
v_lshlrev_b32 v244, 16, v82
v_and_b32 v245, 0xffff0000, v82
v_fma_f32 v240, v240, v10, v9
v_fma_f32 v241, v241, v10, v9
v_cvt_pk_bf16_f32 v80, v240, v241
v_lshlrev_b32 v246, 16, v83
v_and_b32 v247, 0xffff0000, v83
v_mfma_f32_32x32x16_bf16 v[208:223], a[248:251], v[76:79], v[208:223]
ds_read_b64_tr_b16 a[240:241], v251 offset:8256
ds_read_b64_tr_b16 a[242:243], v251 offset:8768
v_fma_f32 v242, v242, v10, v9
v_fma_f32 v243, v243, v10, v9
v_cvt_pk_bf16_f32 v81, v242, v243
v_lshlrev_b32 v240, 16, v84
v_and_b32 v241, 0xffff0000, v84
v_fma_f32 v244, v244, v10, v9
v_fma_f32 v245, v245, v10, v9
v_mfma_f32_32x32x16_bf16 v[224:239], v[76:79], a[252:255], v[224:239]
s_waitcnt lgkmcnt(6)
ds_read_b64_tr_b16 a[244:245], v250 offset:10336
ds_read_b64_tr_b16 a[246:247], v250 offset:10848
v_cvt_pk_bf16_f32 v82, v244, v245
v_lshlrev_b32 v242, 16, v85
v_and_b32 v243, 0xffff0000, v85
v_fma_f32 v246, v246, v10, v9
v_fma_f32 v247, v247, v10, v9
v_cvt_pk_bf16_f32 v83, v246, v247
s_nop 1
v_mfma_f32_32x32x16_bf16 v[192:207], a[224:227], v[80:83], v[192:207]
s_add_u32 m0, s43, 132096
ds_read_b64_tr_b16 a[248:249], v250 offset:12384
ds_read_b64_tr_b16 a[250:251], v250 offset:12896
buffer_load_dwordx4 v7, s[8:11], s46 offen lds
s_add_u32 s46, s46, 57344
v_lshlrev_b32 v244, 16, v86
v_and_b32 v245, 0xffff0000, v86
v_fma_f32 v240, v240, v10, v9
v_fma_f32 v241, v241, v10, v9
v_cvt_pk_bf16_f32 v84, v240, v241
v_lshlrev_b32 v246, 16, v87
v_and_b32 v247, 0xffff0000, v87
v_mov_b32 v140, -1
v_mov_b32 v141, -1
v_mfma_f32_32x32x16_bf16 v[208:223], a[228:231], v[80:83], v[208:223]
s_waitcnt lgkmcnt(6)
ds_read_b64_tr_b16 a[252:253], v251 offset:12384
ds_read_b64_tr_b16 a[254:255], v251 offset:12896
v_fma_f32 v242, v242, v10, v9
v_fma_f32 v243, v243, v10, v9
v_cvt_pk_bf16_f32 v85, v242, v243
v_lshlrev_b32 v240, 16, v88
v_and_b32 v241, 0xffff0000, v88
v_fma_f32 v244, v244, v10, v9
v_fma_f32 v245, v245, v10, v9
v_mov_b32 v142, -1
v_mov_b32 v143, -1
v_mfma_f32_32x32x16_bf16 v[224:239], v[80:83], a[232:235], v[224:239]
ds_read_b64_tr_b16 a[224:225], v250 offset:14464
ds_read_b64_tr_b16 a[226:227], v250 offset:14976
v_cvt_pk_bf16_f32 v86, v244, v245
v_lshlrev_b32 v242, 16, v89
v_and_b32 v243, 0xffff0000, v89
v_fma_f32 v246, v246, v10, v9
v_fma_f32 v247, v247, v10, v9
v_cvt_pk_bf16_f32 v87, v246, v247
v_mov_b32 v13, 0
s_nop 0
v_mfma_f32_32x32x16_bf16 v[192:207], a[236:239], v[84:87], v[192:207]
s_add_u32 m0, s43, 136224
s_waitcnt lgkmcnt(6)
ds_read_b64_tr_b16 a[228:229], v250 offset:16512
ds_read_b64_tr_b16 a[230:231], v250 offset:17024
buffer_load_dwordx4 v7, s[8:11], s46 offen lds
s_add_u32 s46, s46, 57344
v_lshlrev_b32 v244, 16, v90
v_and_b32 v245, 0xffff0000, v90
v_fma_f32 v240, v240, v10, v9
v_fma_f32 v241, v241, v10, v9
v_cvt_pk_bf16_f32 v88, v240, v241
v_lshlrev_b32 v246, 16, v91
v_and_b32 v247, 0xffff0000, v91
buffer_store_dwordx4 v[140:143], v0, s[16:19], s54 offen sc1
buffer_store_dwordx4 v[140:143], v0, s[16:19], s54 offen offset:2048 sc1
v_mfma_f32_32x32x16_bf16 v[208:223], a[240:243], v[84:87], v[208:223]
ds_read_b64_tr_b16 a[232:233], v251 offset:16512
ds_read_b64_tr_b16 a[234:235], v251 offset:17024
v_fma_f32 v242, v242, v10, v9
v_fma_f32 v243, v243, v10, v9
v_cvt_pk_bf16_f32 v89, v242, v243
v_lshlrev_b32 v240, 16, v92
v_and_b32 v241, 0xffff0000, v92
v_fma_f32 v244, v244, v10, v9
v_fma_f32 v245, v245, v10, v9
buffer_store_dword v13, v15, s[16:19], s55 offen sc1
v_mfma_f32_32x32x16_bf16 v[224:239], v[84:87], a[244:247], v[224:239]
s_waitcnt lgkmcnt(6)
ds_read_b64_tr_b16 a[236:237], v250 offset:18592
ds_read_b64_tr_b16 a[238:239], v250 offset:19104
v_cvt_pk_bf16_f32 v90, v244, v245
v_lshlrev_b32 v242, 16, v93
v_and_b32 v243, 0xffff0000, v93
v_fma_f32 v246, v246, v10, v9
v_fma_f32 v247, v247, v10, v9
v_cvt_pk_bf16_f32 v91, v246, v247
buffer_store_dword v13, v15, s[16:19], s58 offen sc1
s_nop 0
v_mfma_f32_32x32x16_bf16 v[192:207], a[248:251], v[88:91], v[192:207]
s_add_u32 m0, s43, 140352
s_waitcnt vmcnt(14)
s_barrier
ds_read_b64_tr_b16 a[240:241], v250 offset:20640
ds_read_b64_tr_b16 a[242:243], v250 offset:21152
buffer_load_dwordx4 v7, s[8:11], s46 offen lds
s_add_u32 s46, s46, 57344
v_lshlrev_b32 v244, 16, v94
v_and_b32 v245, 0xffff0000, v94
v_fma_f32 v240, v240, v10, v9
v_fma_f32 v241, v241, v10, v9
v_cvt_pk_bf16_f32 v92, v240, v241
v_lshlrev_b32 v246, 16, v95
v_and_b32 v247, 0xffff0000, v95
ds_read_b64_tr_b16 v[128:129], v148
v_mfma_f32_32x32x16_bf16 v[208:223], a[252:255], v[88:91], v[208:223]
s_waitcnt lgkmcnt(7)
ds_read_b64_tr_b16 a[244:245], v251 offset:20640
ds_read_b64_tr_b16 a[246:247], v251 offset:21152
v_fma_f32 v242, v242, v10, v9
v_fma_f32 v243, v243, v10, v9
v_cvt_pk_bf16_f32 v93, v242, v243
v_lshlrev_b32 v240, 16, v96
v_and_b32 v241, 0xffff0000, v96
v_fma_f32 v244, v244, v10, v9
v_fma_f32 v245, v245, v10, v9
ds_read_b64_tr_b16 v[130:131], v148 offset:1024
ds_read_b64_tr_b16 v[132:133], v149
v_mfma_f32_32x32x16_bf16 v[224:239], v[88:91], a[224:227], v[224:239]
ds_read_b64_tr_b16 a[248:249], v250 offset:22720
ds_read_b64_tr_b16 a[250:251], v250 offset:23232
v_cvt_pk_bf16_f32 v94, v244, v245
v_lshlrev_b32 v242, 16, v97
v_and_b32 v243, 0xffff0000, v97
v_fma_f32 v246, v246, v10, v9
v_fma_f32 v247, v247, v10, v9
v_cvt_pk_bf16_f32 v95, v246, v247
ds_read_b64_tr_b16 v[134:135], v149 offset:1024
s_nop 0
v_mfma_f32_32x32x16_bf16 v[192:207], a[228:231], v[92:95], v[192:207]
s_add_u32 m0, s43, 144480
s_waitcnt lgkmcnt(10)
ds_read_b64_tr_b16 a[252:253], v250 offset:24768
ds_read_b64_tr_b16 a[254:255], v250 offset:25280
buffer_load_dwordx4 v7, s[8:11], s46 offen lds
s_add_u32 s46, s46, 57344
s_sub_u32 s3, s46, 1605632
s_cmp_eq_u32 s3, s47
s_cselect_b32 s46, s47, s46
v_lshlrev_b32 v244, 16, v98
v_and_b32 v245, 0xffff0000, v98
v_fma_f32 v240, v240, v10, v9
v_fma_f32 v241, v241, v10, v9
v_cvt_pk_bf16_f32 v96, v240, v241
v_lshlrev_b32 v246, 16, v99
v_and_b32 v247, 0xffff0000, v99
v_mfma_f32_32x32x16_bf16 v[208:223], a[232:235], v[92:95], v[208:223]
ds_read_b64_tr_b16 a[224:225], v251 offset:24768
ds_read_b64_tr_b16 a[226:227], v251 offset:25280
v_fma_f32 v242, v242, v10, v9
v_fma_f32 v243, v243, v10, v9
v_cvt_pk_bf16_f32 v97, v242, v243
v_lshlrev_b32 v240, 16, v100
v_and_b32 v241, 0xffff0000, v100
v_fma_f32 v244, v244, v10, v9
v_fma_f32 v245, v245, v10, v9
v_mfma_f32_32x32x16_bf16 v[224:239], v[92:95], a[236:239], v[224:239]
s_waitcnt lgkmcnt(9)
ds_read_b64_tr_b16 a[228:229], v250 offset:26848
ds_read_b64_tr_b16 a[230:231], v250 offset:27360
v_cvt_pk_bf16_f32 v98, v244, v245
v_lshlrev_b32 v242, 16, v101
v_and_b32 v243, 0xffff0000, v101
v_fma_f32 v246, v246, v10, v9
v_fma_f32 v247, v247, v10, v9
v_cvt_pk_bf16_f32 v99, v246, v247
s_nop 1
v_mfma_f32_32x32x16_bf16 v[192:207], a[240:243], v[96:99], v[192:207]
s_add_u32 m0, s43, 148608
ds_read_b64_tr_b16 a[232:233], v250 offset:28896
ds_read_b64_tr_b16 a[234:235], v250 offset:29408
buffer_load_dwordx4 v7, s[8:11], s46 offen lds
s_add_u32 s46, s46, 57344
v_lshlrev_b32 v244, 16, v102
v_and_b32 v245, 0xffff0000, v102
v_fma_f32 v240, v240, v10, v9
v_fma_f32 v241, v241, v10, v9
v_cvt_pk_bf16_f32 v100, v240, v241
v_lshlrev_b32 v246, 16, v103
v_and_b32 v247, 0xffff0000, v103
s_waitcnt lgkmcnt(12)
buffer_store_dwordx4 v[128:131], v0, s[16:19], s52 offen offset:0 sc1
v_mfma_f32_32x32x16_bf16 v[208:223], a[244:247], v[96:99], v[208:223]
s_waitcnt lgkmcnt(6)
ds_read_b64_tr_b16 a[236:237], v251 offset:28896
ds_read_b64_tr_b16 a[238:239], v251 offset:29408
v_fma_f32 v242, v242, v10, v9
v_fma_f32 v243, v243, v10, v9
v_cvt_pk_bf16_f32 v101, v242, v243
v_lshlrev_b32 v240, 16, v104
v_and_b32 v241, 0xffff0000, v104
v_fma_f32 v244, v244, v10, v9
v_fma_f32 v245, v245, v10, v9
v_mfma_f32_32x32x16_bf16 v[224:239], v[96:99], a[248:251], v[224:239]
ds_read_b64_tr_b16 a[240:241], v250 offset:30976
ds_read_b64_tr_b16 a[242:243], v250 offset:31488
v_cvt_pk_bf16_f32 v102, v244, v245
v_lshlrev_b32 v242, 16, v105
v_and_b32 v243, 0xffff0000, v105
v_fma_f32 v246, v246, v10, v9
v_fma_f32 v247, v247, v10, v9
v_cvt_pk_bf16_f32 v103, v246, v247
buffer_store_dwordx4 v[132:135], v0, s[16:19], s52 offen offset:1024 sc1
s_nop 0
v_mfma_f32_32x32x16_bf16 v[192:207], a[252:255], v[100:103], v[192:207]
s_add_u32 m0, s43, 0
s_waitcnt lgkmcnt(6)
ds_read_b64_tr_b16 a[244:245], v250 offset:33024
ds_read_b64_tr_b16 a[246:247], v250 offset:33536
buffer_load_dwordx4 v7, s[8:11], s46 offen lds
s_add_u32 s46, s46, 57344
v_lshlrev_b32 v244, 16, v106
v_and_b32 v245, 0xffff0000, v106
v_fma_f32 v240, v240, v10, v9
v_fma_f32 v241, v241, v10, v9
v_cvt_pk_bf16_f32 v104, v240, v241
v_lshlrev_b32 v246, 16, v107
v_and_b32 v247, 0xffff0000, v107
v_mfma_f32_32x32x16_bf16 v[208:223], a[224:227], v[100:103], v[208:223]
ds_read_b64_tr_b16 a[248:249], v251 offset:33024
ds_read_b64_tr_b16 a[250:251], v251 offset:33536
v_fma_f32 v242, v242, v10, v9
v_fma_f32 v243, v243, v10, v9
v_cvt_pk_bf16_f32 v105, v242, v243
v_lshlrev_b32 v240, 16, v108
v_and_b32 v241, 0xffff0000, v108
v_fma_f32 v244, v244, v10, v9
v_fma_f32 v245, v245, v10, v9
v_mov_b32 v13, 1
v_mfma_f32_32x32x16_bf16 v[224:239], v[100:103], a[228:231], v[224:239]
s_waitcnt lgkmcnt(6)
ds_read_b64_tr_b16 a[252:253], v250 offset:35104
ds_read_b64_tr_b16 a[254:255], v250 offset:35616
v_cvt_pk_bf16_f32 v106, v244, v245
v_lshlrev_b32 v242, 16, v109
v_and_b32 v243, 0xffff0000, v109
v_fma_f32 v246, v246, v10, v9
v_fma_f32 v247, v247, v10, v9
v_cvt_pk_bf16_f32 v107, v246, v247
s_nop 1
v_mfma_f32_32x32x16_bf16 v[192:207], a[232:235], v[104:107], v[192:207]
s_add_u32 m0, s43, 4128
s_waitcnt vmcnt(16)
s_barrier
ds_read_b64_tr_b16 a[224:225], v250 offset:37152
ds_read_b64_tr_b16 a[226:227], v250 offset:37664
buffer_load_dwordx4 v7, s[8:11], s46 offen lds
s_add_u32 s46, s46, 57344
v_lshlrev_b32 v244, 16, v110
v_and_b32 v245, 0xffff0000, v110
v_fma_f32 v240, v240, v10, v9
v_fma_f32 v241, v241, v10, v9
v_cvt_pk_bf16_f32 v108, v240, v241
v_lshlrev_b32 v246, 16, v111
v_and_b32 v247, 0xffff0000, v111
v_mfma_f32_32x32x16_bf16 v[208:223], a[236:239], v[104:107], v[208:223]
s_waitcnt lgkmcnt(6)
ds_read_b64_tr_b16 a[228:229], v251 offset:37152
ds_read_b64_tr_b16 a[230:231], v251 offset:37664
v_fma_f32 v242, v242, v10, v9
v_fma_f32 v243, v243, v10, v9
v_cvt_pk_bf16_f32 v109, v242, v243
v_lshlrev_b32 v240, 16, v112
v_and_b32 v241, 0xffff0000, v112
v_fma_f32 v244, v244, v10, v9
v_fma_f32 v245, v245, v10, v9
v_mfma_f32_32x32x16_bf16 v[224:239], v[104:107], a[240:243], v[224:239]
ds_read_b64_tr_b16 a[232:233], v250 offset:39232
ds_read_b64_tr_b16 a[234:235], v250 offset:39744
v_cvt_pk_bf16_f32 v110, v244, v245
v_lshlrev_b32 v242, 16, v113
v_and_b32 v243, 0xffff0000, v113
v_fma_f32 v246, v246, v10, v9
v_fma_f32 v247, v247, v10, v9
v_cvt_pk_bf16_f32 v111, v246, v247
s_nop 1
v_mfma_f32_32x32x16_bf16 v[192:207], a[244:247], v[108:111], v[192:207]
s_add_u32 m0, s43, 8256
s_waitcnt lgkmcnt(6)
ds_read_b64_tr_b16 a[236:237], v250 offset:41280
ds_read_b64_tr_b16 a[238:239], v250 offset:41792
buffer_load_dwordx4 v7, s[8:11], s46 offen lds
s_add_u32 s46, s46, 57344
s_sub_u32 s3, s46, 1605632
s_cmp_eq_u32 s3, s47
s_cselect_b32 s46, s47, s46
v_lshlrev_b32 v244, 16, v114
v_and_b32 v245, 0xffff0000, v114
v_fma_f32 v240, v240, v10, v9
v_fma_f32 v241, v241, v10, v9
v_cvt_pk_bf16_f32 v112, v240, v241
v_lshlrev_b32 v246, 16, v115
v_and_b32 v247, 0xffff0000, v115
v_mfma_f32_32x32x16_bf16 v[208:223], a[248:251], v[108:111], v[208:223]
ds_read_b64_tr_b16 a[240:241], v251 offset:41280
ds_read_b64_tr_b16 a[242:243], v251 offset:41792
v_fma_f32 v242, v242, v10, v9
v_fma_f32 v243, v243, v10, v9
v_cvt_pk_bf16_f32 v113, v242, v243
v_lshlrev_b32 v240, 16, v116
v_and_b32 v241, 0xffff0000, v116
v_fma_f32 v244, v244, v10, v9
v_fma_f32 v245, v245, v10, v9
v_mfma_f32_32x32x16_bf16 v[224:239], v[108:111], a[252:255], v[224:239]
s_waitcnt lgkmcnt(6)
ds_read_b64_tr_b16 a[244:245], v250 offset:43360
ds_read_b64_tr_b16 a[246:247], v250 offset:43872
v_cvt_pk_bf16_f32 v114, v244, v245
v_lshlrev_b32 v242, 16, v117
v_and_b32 v243, 0xffff0000, v117
v_fma_f32 v246, v246, v10, v9
v_fma_f32 v247, v247, v10, v9
v_cvt_pk_bf16_f32 v115, v246, v247
s_nop 1
v_mfma_f32_32x32x16_bf16 v[192:207], a[224:227], v[112:115], v[192:207]
s_add_u32 m0, s43, 12384
ds_read_b64_tr_b16 a[248:249], v250 offset:45408
ds_read_b64_tr_b16 a[250:251], v250 offset:45920
buffer_load_dwordx4 v7, s[8:11], s46 offen lds
s_add_u32 s46, s46, 57344
v_lshlrev_b32 v244, 16, v118
v_and_b32 v245, 0xffff0000, v118
v_fma_f32 v240, v240, v10, v9
v_fma_f32 v241, v241, v10, v9
v_cvt_pk_bf16_f32 v116, v240, v241
v_lshlrev_b32 v246, 16, v119
v_and_b32 v247, 0xffff0000, v119
v_mfma_f32_32x32x16_bf16 v[208:223], a[228:231], v[112:115], v[208:223]
s_waitcnt lgkmcnt(6)
ds_read_b64_tr_b16 a[252:253], v251 offset:45408
ds_read_b64_tr_b16 a[254:255], v251 offset:45920
v_fma_f32 v242, v242, v10, v9
v_fma_f32 v243, v243, v10, v9
v_cvt_pk_bf16_f32 v117, v242, v243
v_lshlrev_b32 v240, 16, v120
v_and_b32 v241, 0xffff0000, v120
v_fma_f32 v244, v244, v10, v9
v_fma_f32 v245, v245, v10, v9
v_mfma_f32_32x32x16_bf16 v[224:239], v[112:115], a[232:235], v[224:239]
ds_read_b64_tr_b16 a[224:225], v250 offset:47488
ds_read_b64_tr_b16 a[226:227], v250 offset:48000
v_cvt_pk_bf16_f32 v118, v244, v245
v_lshlrev_b32 v242, 16, v121
v_and_b32 v243, 0xffff0000, v121
v_fma_f32 v246, v246, v10, v9
v_fma_f32 v247, v247, v10, v9
v_cvt_pk_bf16_f32 v119, v246, v247
s_nop 1
v_mfma_f32_32x32x16_bf16 v[192:207], a[236:239], v[116:119], v[192:207]
s_add_u32 m0, s43, 16512
s_waitcnt lgkmcnt(6)
ds_read_b64_tr_b16 a[228:229], v250 offset:49536
ds_read_b64_tr_b16 a[230:231], v250 offset:50048
buffer_load_dwordx4 v7, s[8:11], s46 offen lds
s_add_u32 s46, s46, 57344
v_lshlrev_b32 v244, 16, v122
v_and_b32 v245, 0xffff0000, v122
v_fma_f32 v240, v240, v10, v9
v_fma_f32 v241, v241, v10, v9
v_cvt_pk_bf16_f32 v120, v240, v241
v_lshlrev_b32 v246, 16, v123
v_and_b32 v247, 0xffff0000, v123
v_mfma_f32_32x32x16_bf16 v[208:223], a[240:243], v[116:119], v[208:223]
ds_read_b64_tr_b16 a[232:233], v251 offset:49536
ds_read_b64_tr_b16 a[234:235], v251 offset:50048
v_fma_f32 v242, v242, v10, v9
v_fma_f32 v243, v243, v10, v9
v_cvt_pk_bf16_f32 v121, v242, v243
v_lshlrev_b32 v240, 16, v124
v_and_b32 v241, 0xffff0000, v124
v_fma_f32 v244, v244, v10, v9
v_fma_f32 v245, v245, v10, v9
v_mfma_f32_32x32x16_bf16 v[224:239], v[116:119], a[244:247], v[224:239]
s_waitcnt lgkmcnt(6)
ds_read_b64_tr_b16 a[236:237], v250 offset:51616
ds_read_b64_tr_b16 a[238:239], v250 offset:52128
v_cvt_pk_bf16_f32 v122, v244, v245
v_lshlrev_b32 v242, 16, v125
v_and_b32 v243, 0xffff0000, v125
v_fma_f32 v246, v246, v10, v9
v_fma_f32 v247, v247, v10, v9
v_cvt_pk_bf16_f32 v123, v246, v247
s_nop 1
v_mfma_f32_32x32x16_bf16 v[192:207], a[248:251], v[120:123], v[192:207]
s_add_u32 m0, s43, 20640
s_waitcnt vmcnt(16)
s_barrier
ds_read_b64_tr_b16 a[240:241], v3 offset:53664
ds_read_b64_tr_b16 a[242:243], v3 offset:54176
buffer_load_dwordx4 v7, s[8:11], s46 offen lds
s_add_u32 s46, s46, 57344
v_lshlrev_b32 v244, 16, v126
v_and_b32 v245, 0xffff0000, v126
v_fma_f32 v240, v240, v10, v9
v_fma_f32 v241, v241, v10, v9
v_cvt_pk_bf16_f32 v124, v240, v241
v_lshlrev_b32 v246, 16, v127
v_mfma_f32_32x32x16_bf16 v[208:223], a[252:255], v[120:123], v[208:223]
s_waitcnt lgkmcnt(6)
ds_read_b64_tr_b16 a[244:245], v3 offset:53696
ds_read_b64_tr_b16 a[246:247], v3 offset:54208
v_and_b32 v247, 0xffff0000, v127
v_fma_f32 v242, v242, v10, v9
v_fma_f32 v243, v243, v10, v9
v_cvt_pk_bf16_f32 v125, v242, v243
v_fma_f32 v244, v244, v10, v9
v_mfma_f32_32x32x16_bf16 v[224:239], v[120:123], a[224:227], v[224:239]
ds_read_b64_tr_b16 a[248:249], v4 offset:53664
ds_read_b64_tr_b16 a[250:251], v4 offset:54176
v_fma_f32 v245, v245, v10, v9
v_cvt_pk_bf16_f32 v126, v244, v245
v_fma_f32 v246, v246, v10, v9
v_fma_f32 v247, v247, v10, v9
v_cvt_pk_bf16_f32 v127, v246, v247
s_nop 1
v_mfma_f32_32x32x16_bf16 v[192:207], a[228:231], v[124:127], v[192:207]
s_add_u32 m0, s43, 24768
s_waitcnt lgkmcnt(6)
ds_read_b64_tr_b16 a[252:253], v4 offset:53696
ds_read_b64_tr_b16 a[254:255], v4 offset:54208
buffer_load_dwordx4 v7, s[8:11], s46 offen lds
s_add_u32 s46, s46, 57344
s_sub_u32 s3, s46, 1605632
s_cmp_eq_u32 s3, s47
s_cselect_b32 s46, s47, s46
v_mfma_f32_32x32x16_bf16 v[208:223], a[232:235], v[124:127], v[208:223]
ds_read_b64_tr_b16 a[224:225], v3 offset:57792
ds_read_b64_tr_b16 a[226:227], v3 offset:58304
v_mfma_f32_32x32x16_bf16 v[224:239], v[124:127], a[236:239], v[224:239]
s_waitcnt lgkmcnt(6)
ds_read_b64_tr_b16 a[228:229], v3 offset:57824
ds_read_b64_tr_b16 a[230:231], v3 offset:58336
v_mfma_f32_32x32x16_bf16 v[128:143], a[240:243], v[16:19], 0
s_add_u32 m0, s43, 28896
ds_read_b64_tr_b16 a[232:233], v4 offset:57792
ds_read_b64_tr_b16 a[234:235], v4 offset:58304
buffer_load_dwordx4 v7, s[8:11], s46 offen lds
s_add_u32 s46, s46, 57344
v_mfma_f32_32x32x16_bf16 v[144:159], a[244:247], v[16:19], 0
s_waitcnt lgkmcnt(6)
ds_read_b64_tr_b16 a[236:237], v4 offset:57824
ds_read_b64_tr_b16 a[238:239], v4 offset:58336
v_mfma_f32_32x32x16_bf16 v[160:175], a[248:251], v[16:19], 0
ds_read_b64_tr_b16 a[240:241], v5 offset:0
ds_read_b64_tr_b16 a[242:243], v5 offset:512
v_cvt_pk_bf16_f32 v208, v208, v209
v_cvt_pk_bf16_f32 v209, v210, v211
v_cvt_pk_bf16_f32 v210, v212, v213
v_cvt_pk_bf16_f32 v211, v214, v215
v_mfma_f32_32x32x16_bf16 v[176:191], a[252:255], v[16:19], 0
s_waitcnt lgkmcnt(6)
ds_read_b64_tr_b16 a[244:245], v5 offset:32
ds_read_b64_tr_b16 a[246:247], v5 offset:544
buffer_store_dwordx4 v[208:211], v0, s[16:19], s51 offen offset:0 sc1
v_cvt_pk_bf16_f32 v212, v216, v217
v_cvt_pk_bf16_f32 v213, v218, v219
v_mfma_f32_32x32x16_bf16 v[128:143], a[224:227], v[20:23], v[128:143]
s_add_u32 m0, s43, 33024
ds_read_b64_tr_b16 a[248:249], v6 offset:0
ds_read_b64_tr_b16 a[250:251], v6 offset:512
buffer_load_dwordx4 v7, s[8:11], s46 offen lds
s_add_u32 s46, s46, 57344
v_cvt_pk_bf16_f32 v214, v220, v221
v_cvt_pk_bf16_f32 v215, v222, v223
buffer_store_dwordx4 v[212:215], v0, s[16:19], s51 offen offset:1024 sc1
v_mfma_f32_32x32x16_bf16 v[144:159], a[228:231], v[20:23], v[144:159]
s_waitcnt lgkmcnt(6)
ds_read_b64_tr_b16 a[252:253], v6 offset:32
ds_read_b64_tr_b16 a[254:255], v6 offset:544
v_cvt_pk_bf16_f32 v224, v224, v225
v_cndmask_b32 v224, v224, v12, s[38:39]
v_cvt_pk_bf16_f32 v225, v226, v227
v_cndmask_b32 v225, v225, v12, s[38:39]
v_mfma_f32_32x32x16_bf16 v[160:175], a[232:235], v[20:23], v[160:175]
ds_read_b64_tr_b16 a[224:225], v5 offset:4128
ds_read_b64_tr_b16 a[226:227], v5 offset:4640
v_cvt_pk_bf16_f32 v226, v228, v229
v_cndmask_b32 v226, v226, v12, s[38:39]
v_cvt_pk_bf16_f32 v227, v230, v231
v_mfma_f32_32x32x16_bf16 v[176:191], a[236:239], v[20:23], v[176:191]
s_waitcnt lgkmcnt(6)
ds_read_b64_tr_b16 a[228:229], v5 offset:4160
ds_read_b64_tr_b16 a[230:231], v5 offset:4672
v_cndmask_b32 v227, v227, v12, s[38:39]
buffer_store_dwordx4 v[224:227], v0, s[16:19], s51 offen offset:2048 sc1
v_cvt_pk_bf16_f32 v228, v232, v233
v_mfma_f32_32x32x16_bf16 v[128:143], a[240:243], v[24:27], v[128:143]
s_add_u32 m0, s43, 37152
ds_read_b64_tr_b16 a[232:233], v6 offset:4128
ds_read_b64_tr_b16 a[234:235], v6 offset:4640
buffer_load_dwordx4 v7, s[8:11], s46 offen lds
s_add_u32 s46, s46, 57344
v_cndmask_b32 v228, v228, v12, s[38:39]
v_cvt_pk_bf16_f32 v229, v234, v235
v_cndmask_b32 v229, v229, v12, s[38:39]
v_cvt_pk_bf16_f32 v230, v236, v237
v_mfma_f32_32x32x16_bf16 v[144:159], a[244:247], v[24:27], v[144:159]
s_waitcnt lgkmcnt(6)
ds_read_b64_tr_b16 a[236:237], v6 offset:4160
ds_read_b64_tr_b16 a[238:239], v6 offset:4672
v_cndmask_b32 v230, v230, v12, s[38:39]
v_cvt_pk_bf16_f32 v231, v238, v239
v_cndmask_b32 v231, v231, v12, s[38:39]
v_mfma_f32_32x32x16_bf16 v[160:175], a[248:251], v[24:27], v[160:175]
s_waitcnt vmcnt(16)
s_barrier
ds_read_b64_tr_b16 a[240:241], v5 offset:8256
ds_read_b64_tr_b16 a[242:243], v5 offset:8768
buffer_store_dwordx4 v[228:231], v0, s[16:19], s51 offen offset:3072 sc1
v_mul_f32 v192, 0x3e8b97f6, v192
v_mul_f32 v193, 0x3e8b97f6, v193
v_mfma_f32_32x32x16_bf16 v[176:191], a[252:255], v[24:27], v[176:191]
s_waitcnt lgkmcnt(6)
ds_read_b64_tr_b16 a[244:245], v5 offset:8288
ds_read_b64_tr_b16 a[246:247], v5 offset:8800
v_cvt_pk_bf16_f32 v192, v192, v193
v_mul_f32 v194, 0x3e8b97f6, v194
v_mul_f32 v195, 0x3e8b97f6, v195
v_mfma_f32_32x32x16_bf16 v[128:143], a[224:227], v[28:31], v[128:143]
s_add_u32 m0, s43, 41280
ds_read_b64_tr_b16 a[248:249], v6 offset:8256
ds_read_b64_tr_b16 a[250:251], v6 offset:8768
buffer_load_dwordx4 v7, s[8:11], s46 offen lds
s_add_u32 s46, s46, 57344
s_sub_u32 s3, s46, 1605632
s_cmp_eq_u32 s3, s47
s_cselect_b32 s46, s47, s46
v_cvt_pk_bf16_f32 v193, v194, v195
v_mul_f32 v196, 0x3e8b97f6, v196
v_mul_f32 v197, 0x3e8b97f6, v197
v_cvt_pk_bf16_f32 v194, v196, v197
v_mfma_f32_32x32x16_bf16 v[144:159], a[228:231], v[28:31], v[144:159]
s_waitcnt lgkmcnt(6)
ds_read_b64_tr_b16 a[252:253], v6 offset:8288
ds_read_b64_tr_b16 a[254:255], v6 offset:8800
v_mul_f32 v198, 0x3e8b97f6, v198
v_mul_f32 v199, 0x3e8b97f6, v199
v_cvt_pk_bf16_f32 v195, v198, v199
v_mfma_f32_32x32x16_bf16 v[160:175], a[232:235], v[28:31], v[160:175]
ds_read_b64_tr_b16 a[224:225], v5 offset:12384
ds_read_b64_tr_b16 a[226:227], v5 offset:12896
buffer_store_dwordx4 v[192:195], v0, s[16:19], s50 offen offset:0 sc1
v_mul_f32 v200, 0x3e8b97f6, v200
v_mul_f32 v201, 0x3e8b97f6, v201
v_mfma_f32_32x32x16_bf16 v[176:191], a[236:239], v[28:31], v[176:191]
s_waitcnt lgkmcnt(6)
ds_read_b64_tr_b16 a[228:229], v5 offset:12416
ds_read_b64_tr_b16 a[230:231], v5 offset:12928
v_cvt_pk_bf16_f32 v196, v200, v201
v_mul_f32 v202, 0x3e8b97f6, v202
v_mul_f32 v203, 0x3e8b97f6, v203
v_cvt_pk_bf16_f32 v197, v202, v203
v_mfma_f32_32x32x16_bf16 v[128:143], a[240:243], v[32:35], v[128:143]
s_add_u32 m0, s43, 45408
ds_read_b64_tr_b16 a[232:233], v6 offset:12384
ds_read_b64_tr_b16 a[234:235], v6 offset:12896
buffer_load_dwordx4 v7, s[8:11], s46 offen lds
s_add_u32 s46, s46, 57344
v_mov_b32 v9, 1
v_mul_f32 v204, 0x3e8b97f6, v204
v_mul_f32 v205, 0x3e8b97f6, v205
v_cvt_pk_bf16_f32 v198, v204, v205
v_mfma_f32_32x32x16_bf16 v[144:159], a[244:247], v[32:35], v[144:159]
s_waitcnt lgkmcnt(6)
ds_read_b64_tr_b16 a[236:237], v6 offset:12416
ds_read_b64_tr_b16 a[238:239], v6 offset:12928
v_cndmask_b32 v198, 0, v198, s[44:45]
v_mul_f32 v206, 0x3e8b97f6, v206
v_mul_f32 v207, 0x3e8b97f6, v207
v_mfma_f32_32x32x16_bf16 v[160:175], a[248:251], v[32:35], v[160:175]
ds_read_b64_tr_b16 a[240:241], v5 offset:16512
ds_read_b64_tr_b16 a[242:243], v5 offset:17024
v_cvt_pk_bf16_f32 v199, v206, v207
v_cndmask_b32 v199, 0, v199, s[44:45]
buffer_store_dwordx4 v[196:199], v0, s[16:19], s50 offen offset:1024 sc1
v_mfma_f32_32x32x16_bf16 v[176:191], a[252:255], v[32:35], v[176:191]
s_waitcnt lgkmcnt(6)
ds_read_b64_tr_b16 a[244:245], v5 offset:16544
ds_read_b64_tr_b16 a[246:247], v5 offset:17056
v_mfma_f32_32x32x16_bf16 v[128:143], a[224:227], v[36:39], v[128:143]
s_add_u32 m0, s43, 49536
ds_read_b64_tr_b16 a[248:249], v6 offset:16512
ds_read_b64_tr_b16 a[250:251], v6 offset:17024
buffer_load_dwordx4 v7, s[8:11], s46 offen lds
s_add_u32 s46, s46, 57344
s_and_b32 s52, s2, 7
s_lshl_b32 s50, s52, 2
v_mfma_f32_32x32x16_bf16 v[144:159], a[228:231], v[36:39], v[144:159]
s_waitcnt lgkmcnt(6)
ds_read_b64_tr_b16 a[252:253], v6 offset:16544
ds_read_b64_tr_b16 a[254:255], v6 offset:17056
s_lshl_b32 s52, s52, 1
v_mfma_f32_32x32x16_bf16 v[160:175], a[232:235], v[36:39], v[160:175]
ds_read_b64_tr_b16 a[224:225], v5 offset:20640
ds_read_b64_tr_b16 a[226:227], v5 offset:21152
s_bfe_u32 s36, s2, 0x10003
v_mfma_f32_32x32x16_bf16 v[176:191], a[236:239], v[36:39], v[176:191]
s_waitcnt lgkmcnt(6)
ds_read_b64_tr_b16 a[228:229], v5 offset:20672
ds_read_b64_tr_b16 a[230:231], v5 offset:21184
s_add_u32 s52, s52, s36
v_mfma_f32_32x32x16_bf16 v[128:143], a[240:243], v[40:43], v[128:143]
s_add_u32 m0, s43, 53664
ds_read_b64_tr_b16 a[232:233], v6 offset:20640
ds_read_b64_tr_b16 a[234:235], v6 offset:21152
buffer_load_dwordx4 v7, s[8:11], s46 offen lds
s_add_u32 s46, s46, 57344
s_lshr_b32 s54, s2, 4
s_lshr_b32 s62, s2, 3
v_mfma_f32_32x32x16_bf16 v[144:159], a[244:247], v[40:43], v[144:159]
s_waitcnt lgkmcnt(6)
ds_read_b64_tr_b16 a[236:237], v6 offset:20672
ds_read_b64_tr_b16 a[238:239], v6 offset:21184
s_mul_i32 s36, s62, 37
v_mfma_f32_32x32x16_bf16 v[160:175], a[248:251], v[40:43], v[160:175]
s_waitcnt vmcnt(17)
s_barrier
ds_read_b64_tr_b16 a[240:241], v5 offset:24768
ds_read_b64_tr_b16 a[242:243], v5 offset:25280
s_lshr_b32 s36, s36, 8
v_mfma_f32_32x32x16_bf16 v[176:191], a[252:255], v[40:43], v[176:191]
s_waitcnt lgkmcnt(6)
ds_read_b64_tr_b16 a[244:245], v5 offset:24800
ds_read_b64_tr_b16 a[246:247], v5 offset:25312
s_add_u32 s50, s50, s36
v_mfma_f32_32x32x16_bf16 v[128:143], a[224:227], v[44:47], v[128:143]
s_add_u32 m0, s43, 57792
ds_read_b64_tr_b16 a[248:249], v6 offset:24768
ds_read_b64_tr_b16 a[250:251], v6 offset:25280
buffer_load_dwordx4 v7, s[8:11], s46 offen lds
s_add_u32 s46, s46, 57344
s_sub_u32 s3, s46, 1605632
s_cmp_eq_u32 s3, s47
s_cselect_b32 s46, s47, s46
s_mul_i32 s36, s36, 7
v_mfma_f32_32x32x16_bf16 v[144:159], a[228:231], v[44:47], v[144:159]
s_waitcnt lgkmcnt(6)
ds_read_b64_tr_b16 a[252:253], v6 offset:24800
ds_read_b64_tr_b16 a[254:255], v6 offset:25312
s_sub_u32 s51, s62, s36
s_lshl_b32 s36, s52, 17
v_mfma_f32_32x32x16_bf16 v[160:175], a[232:235], v[44:47], v[160:175]
ds_read_b64_tr_b16 a[224:225], v1 offset:0
ds_read_b64_tr_b16 a[226:227], v1 offset:512
s_lshl_b32 s37, s54, 13
v_mfma_f32_32x32x16_bf16 v[176:191], a[236:239], v[44:47], v[176:191]
s_waitcnt lgkmcnt(6)
ds_read_b64_tr_b16 a[228:229], v1 offset:32
ds_read_b64_tr_b16 a[230:231], v1 offset:544
s_add_u32 s36, s36, s37
v_mfma_f32_32x32x16_bf16 v[128:143], a[240:243], v[48:51], v[128:143]
s_add_u32 m0, s43, 61920
ds_read_b64_tr_b16 a[232:233], v2 offset:0
ds_read_b64_tr_b16 a[234:235], v2 offset:512
buffer_load_dwordx4 v7, s[8:11], s46 offen lds
s_add_u32 s46, s46, 57344
s_lshl_b32 s37, s40, 11
v_mfma_f32_32x32x16_bf16 v[144:159], a[244:247], v[48:51], v[144:159]
s_waitcnt lgkmcnt(6)
ds_read_b64_tr_b16 a[236:237], v2 offset:32
ds_read_b64_tr_b16 a[238:239], v2 offset:544
s_add_u32 s56, s36, s37
v_mfma_f32_32x32x16_bf16 v[160:175], a[248:251], v[48:51], v[160:175]
ds_read_b64_tr_b16 a[240:241], v1 offset:4128
ds_read_b64_tr_b16 a[242:243], v1 offset:4640
s_xor_b32 s57, s56, 0x800
s_xor_b32 s41, s56, 0x1000
v_mfma_f32_32x32x16_bf16 v[176:191], a[252:255], v[48:51], v[176:191]
s_waitcnt lgkmcnt(6)
ds_read_b64_tr_b16 a[244:245], v1 offset:4160
ds_read_b64_tr_b16 a[246:247], v1 offset:4672
s_xor_b32 s42, s56, 0x1800
v_mfma_f32_32x32x16_bf16 v[128:143], a[224:227], v[52:55], v[128:143]
s_add_u32 m0, s43, 66048
ds_read_b64_tr_b16 a[248:249], v2 offset:4128
ds_read_b64_tr_b16 a[250:251], v2 offset:4640
buffer_load_dwordx4 v7, s[8:11], s46 offen lds
s_add_u32 s46, s46, 57344
s_lshl_b32 s36, s52, 18
v_mfma_f32_32x32x16_bf16 v[144:159], a[228:231], v[52:55], v[144:159]
s_waitcnt lgkmcnt(6)
ds_read_b64_tr_b16 a[252:253], v2 offset:4160
ds_read_b64_tr_b16 a[254:255], v2 offset:4672
s_add_u32 s64, s36, 2097152
v_mfma_f32_32x32x16_bf16 v[160:175], a[232:235], v[52:55], v[160:175]
ds_read_b64_tr_b16 a[224:225], v1 offset:8256
ds_read_b64_tr_b16 a[226:227], v1 offset:8768
s_lshl_b32 s37, s40, 16
v_mfma_f32_32x32x16_bf16 v[176:191], a[236:239], v[52:55], v[176:191]
s_waitcnt lgkmcnt(6)
ds_read_b64_tr_b16 a[228:229], v1 offset:8288
ds_read_b64_tr_b16 a[230:231], v1 offset:8800
s_add_u32 s61, s64, s37
v_lshlrev_b32 v8, 3, v0
v_mfma_f32_32x32x16_bf16 v[128:143], a[240:243], v[56:59], v[128:143]
s_add_u32 m0, s43, 70176
ds_read_b64_tr_b16 a[232:233], v2 offset:8256
ds_read_b64_tr_b16 a[234:235], v2 offset:8768
buffer_load_dwordx4 v7, s[8:11], s46 offen lds
s_add_u32 s46, s46, 57344
v_lshrrev_b32 v10, 2, v0
v_mfma_f32_32x32x16_bf16 v[144:159], a[244:247], v[56:59], v[144:159]
s_waitcnt lgkmcnt(6)
ds_read_b64_tr_b16 a[236:237], v2 offset:8288
ds_read_b64_tr_b16 a[238:239], v2 offset:8800
v_and_b32 v10, 0, v10
v_mfma_f32_32x32x16_bf16 v[160:175], a[248:251], v[56:59], v[160:175]
s_waitcnt vmcnt(17)
s_barrier
ds_read_b64_tr_b16 a[240:241], v1 offset:12384
ds_read_b64_tr_b16 a[242:243], v1 offset:12896
v_and_b32 v8, 0x380, v8
v_mfma_f32_32x32x16_bf16 v[176:191], a[252:255], v[56:59], v[176:191]
s_waitcnt lgkmcnt(6)
ds_read_b64_tr_b16 a[244:245], v1 offset:12416
ds_read_b64_tr_b16 a[246:247], v1 offset:12928
s_mov_b32 s24, s16
v_mfma_f32_32x32x16_bf16 v[128:143], a[224:227], v[60:63], v[128:143]
s_add_u32 m0, s43, 74304
ds_read_b64_tr_b16 a[248:249], v2 offset:12384
ds_read_b64_tr_b16 a[250:251], v2 offset:12896
buffer_load_dwordx4 v7, s[8:11], s46 offen lds
s_add_u32 s46, s0, s1
s_mov_b32 s25, s17
s_mov_b32 s27, 0x00020000
v_mfma_f32_32x32x16_bf16 v[144:159], a[228:231], v[60:63], v[144:159]
s_waitcnt lgkmcnt(6)
ds_read_b64_tr_b16 a[252:253], v2 offset:12416
ds_read_b64_tr_b16 a[254:255], v2 offset:12928
s_cmp_lt_u32 s62, 28
s_cselect_b32 s26, 268435456, 0
s_cselect_b32 s60, 1, 0
v_mfma_f32_32x32x16_bf16 v[160:175], a[232:235], v[60:63], v[160:175]
ds_read_b64_tr_b16 a[224:225], v1 offset:16512
ds_read_b64_tr_b16 a[226:227], v1 offset:17024
s_mul_i32 s37, s40, 57344
v_mfma_f32_32x32x16_bf16 v[176:191], a[236:239], v[60:63], v[176:191]
s_waitcnt lgkmcnt(6)
ds_read_b64_tr_b16 a[228:229], v1 offset:16544
ds_read_b64_tr_b16 a[230:231], v1 offset:17056
s_mul_i32 s36, s51, 229376
v_mfma_f32_32x32x16_bf16 v[128:143], a[240:243], v[64:67], v[128:143]
s_add_u32 m0, s43, 78432
ds_read_b64_tr_b16 a[232:233], v2 offset:16512
ds_read_b64_tr_b16 a[234:235], v2 offset:17024
buffer_load_dwordx4 v14, s[8:11], s46 offen lds
s_add_u32 s46, s46, 57344
s_add_u32 s36, s36, s37
v_mfma_f32_32x32x16_bf16 v[144:159], a[244:247], v[64:67], v[144:159]
s_waitcnt lgkmcnt(6)
ds_read_b64_tr_b16 a[236:237], v2 offset:16544
ds_read_b64_tr_b16 a[238:239], v2 offset:17056
s_add_u32 s65, s36, 13631488
s_mul_i32 s36, s50, 229376
v_mfma_f32_32x32x16_bf16 v[160:175], a[248:251], v[64:67], v[160:175]
ds_read_b64_tr_b16 a[240:241], v1 offset:20640
ds_read_b64_tr_b16 a[242:243], v1 offset:21152
s_add_u32 s36, s36, s37
v_mfma_f32_32x32x16_bf16 v[176:191], a[252:255], v[64:67], v[176:191]
s_waitcnt lgkmcnt(6)
ds_read_b64_tr_b16 a[244:245], v1 offset:20672
ds_read_b64_tr_b16 a[246:247], v1 offset:21184
s_add_u32 s66, s36, 6291456
v_mfma_f32_32x32x16_bf16 v[128:143], a[224:227], v[68:71], v[128:143]
s_add_u32 m0, s43, 82560
ds_read_b64_tr_b16 a[248:249], v2 offset:20640
ds_read_b64_tr_b16 a[250:251], v2 offset:21152
buffer_load_dwordx4 v14, s[8:11], s46 offen lds
s_add_u32 s46, s46, 57344
s_lshl_b32 s36, s50, 12
v_mfma_f32_32x32x16_bf16 v[144:159], a[228:231], v[68:71], v[144:159]
s_waitcnt lgkmcnt(6)
ds_read_b64_tr_b16 a[252:253], v2 offset:20672
ds_read_b64_tr_b16 a[254:255], v2 offset:21184
s_lshl_b32 s37, s40, 10
v_mfma_f32_32x32x16_bf16 v[160:175], a[232:235], v[68:71], v[160:175]
ds_read_b64_tr_b16 a[224:225], v1 offset:24768
ds_read_b64_tr_b16 a[226:227], v1 offset:25280
s_add_u32 s36, s36, s37
s_add_u32 s63, s36, 18874368
v_mfma_f32_32x32x16_bf16 v[176:191], a[236:239], v[68:71], v[176:191]
s_waitcnt lgkmcnt(6)
ds_read_b64_tr_b16 a[228:229], v1 offset:24800
ds_read_b64_tr_b16 a[230:231], v1 offset:25312
s_and_b32 s36, s40, 1
v_mfma_f32_32x32x16_bf16 v[128:143], a[240:243], v[72:75], v[128:143]
s_add_u32 m0, s43, 86688
ds_read_b64_tr_b16 a[232:233], v2 offset:24768
ds_read_b64_tr_b16 a[234:235], v2 offset:25280
buffer_load_dwordx4 v14, s[8:11], s46 offen lds
s_add_u32 s46, s46, 57344
s_lshr_b32 s37, s40, 1
v_mfma_f32_32x32x16_bf16 v[144:159], a[244:247], v[72:75], v[144:159]
s_waitcnt lgkmcnt(6)
ds_read_b64_tr_b16 a[236:237], v2 offset:24800
ds_read_b64_tr_b16 a[238:239], v2 offset:25312
s_lshl_b32 s38, s36, 10
v_mfma_f32_32x32x16_bf16 v[160:175], a[248:251], v[72:75], v[160:175]
s_waitcnt vmcnt(10)
s_barrier
buffer_atomic_add v9, v11, s[32:35], 0 offen sc0 sc1
ds_read_b64_tr_b16 a[240:241], v1 offset:28896
ds_read_b64_tr_b16 a[242:243], v1 offset:29408
v_add_u32 v240, s38, v0
v_mfma_f32_32x32x16_bf16 v[176:191], a[252:255], v[72:75], v[176:191]
s_waitcnt lgkmcnt(6)
ds_read_b64_tr_b16 a[244:245], v1 offset:28928
ds_read_b64_tr_b16 a[246:247], v1 offset:29440
v_xor_b32 v241, 0x400, v240
s_lshl_b32 s39, s37, 10
v_mfma_f32_32x32x16_bf16 v[128:143], a[224:227], v[76:79], v[128:143]
s_add_u32 m0, s43, 90816
ds_read_b64_tr_b16 a[248:249], v2 offset:28896
ds_read_b64_tr_b16 a[250:251], v2 offset:29408
buffer_load_dwordx4 v14, s[8:11], s46 offen lds
s_add_u32 s46, s46, 57344
s_sub_u32 s3, s46, 1605632
s_cmp_eq_u32 s3, s0
s_cselect_b32 s46, s0, s46
v_add_u32 v242, s39, v0
v_mfma_f32_32x32x16_bf16 v[144:159], a[228:231], v[76:79], v[144:159]
s_waitcnt lgkmcnt(6)
ds_read_b64_tr_b16 a[252:253], v2 offset:28928
ds_read_b64_tr_b16 a[254:255], v2 offset:29440
v_xor_b32 v243, 0x400, v242
v_mfma_f32_32x32x16_bf16 v[160:175], a[232:235], v[76:79], v[160:175]
ds_read_b64_tr_b16 a[224:225], v1 offset:33024
ds_read_b64_tr_b16 a[226:227], v1 offset:33536
s_lshl_b32 s67, s40, 14
v_mfma_f32_32x32x16_bf16 v[176:191], a[236:239], v[76:79], v[176:191]
s_waitcnt lgkmcnt(6)
ds_read_b64_tr_b16 a[228:229], v1 offset:33056
ds_read_b64_tr_b16 a[230:231], v1 offset:33568
s_add_u32 s68, s67, 98304
v_mfma_f32_32x32x16_bf16 v[128:143], a[240:243], v[80:83], v[128:143]
s_add_u32 m0, s43, 94944
ds_read_b64_tr_b16 a[232:233], v2 offset:33024
ds_read_b64_tr_b16 a[234:235], v2 offset:33536
buffer_load_dwordx4 v14, s[8:11], s46 offen lds
s_add_u32 s46, s46, 57344
s_lshl_b32 s53, s51, 16
s_add_u32 s67, s67, s53
v_mfma_f32_32x32x16_bf16 v[144:159], a[244:247], v[80:83], v[144:159]
s_waitcnt lgkmcnt(6)
ds_read_b64_tr_b16 a[236:237], v2 offset:33056
ds_read_b64_tr_b16 a[238:239], v2 offset:33568
s_add_u32 s67, s67, 15237120
v_mfma_f32_32x32x16_bf16 v[160:175], a[248:251], v[80:83], v[160:175]
ds_read_b64_tr_b16 a[240:241], v1 offset:37152
ds_read_b64_tr_b16 a[242:243], v1 offset:37664
s_mul_i32 s53, s36, 0x8400
v_mfma_f32_32x32x16_bf16 v[176:191], a[252:255], v[80:83], v[176:191]
s_waitcnt lgkmcnt(6)
ds_read_b64_tr_b16 a[244:245], v1 offset:37184
ds_read_b64_tr_b16 a[246:247], v1 offset:37696
s_add_u32 s53, s53, 98304
v_mfma_f32_32x32x16_bf16 v[128:143], a[224:227], v[84:87], v[128:143]
s_add_u32 m0, s43, 99072
ds_read_b64_tr_b16 a[248:249], v2 offset:37152
ds_read_b64_tr_b16 a[250:251], v2 offset:37664
buffer_load_dwordx4 v14, s[8:11], s46 offen lds
s_add_u32 s46, s46, 57344
v_add_u32 v253, s53, v0
v_xor_b32 v254, 0x400, v253
v_mfma_f32_32x32x16_bf16 v[144:159], a[228:231], v[84:87], v[144:159]
s_waitcnt lgkmcnt(6)
ds_read_b64_tr_b16 a[252:253], v2 offset:37184
ds_read_b64_tr_b16 a[254:255], v2 offset:37696
s_lshl_b32 s69, s50, 16
v_mfma_f32_32x32x16_bf16 v[160:175], a[232:235], v[84:87], v[160:175]
ds_read_b64_tr_b16 a[224:225], v1 offset:41280
ds_read_b64_tr_b16 a[226:227], v1 offset:41792
s_add_u32 s69, s69, s39
v_mfma_f32_32x32x16_bf16 v[176:191], a[236:239], v[84:87], v[176:191]
s_waitcnt lgkmcnt(6)
ds_read_b64_tr_b16 a[228:229], v1 offset:41312
ds_read_b64_tr_b16 a[230:231], v1 offset:41824
s_lshl_b32 s53, s36, 15
v_mfma_f32_32x32x16_bf16 v[128:143], a[240:243], v[88:91], v[128:143]
s_add_u32 m0, s43, 103200
ds_read_b64_tr_b16 a[232:233], v2 offset:41280
ds_read_b64_tr_b16 a[234:235], v2 offset:41792
buffer_load_dwordx4 v14, s[8:11], s46 offen lds
s_add_u32 s46, s46, 57344
s_add_u32 s69, s69, s53
v_mfma_f32_32x32x16_bf16 v[144:159], a[244:247], v[88:91], v[144:159]
s_waitcnt lgkmcnt(6)
ds_read_b64_tr_b16 a[236:237], v2 offset:41312
ds_read_b64_tr_b16 a[238:239], v2 offset:41824
s_add_u32 s69, s69, 16777216
s_add_u32 s70, s69, 16384
v_mfma_f32_32x32x16_bf16 v[160:175], a[248:251], v[88:91], v[160:175]
s_waitcnt vmcnt(12)
s_barrier
ds_read_b64_tr_b16 a[240:241], v1 offset:45408
ds_read_b64_tr_b16 a[242:243], v1 offset:45920
s_lshl_b32 s71, s54, 1
v_mfma_f32_32x32x16_bf16 v[176:191], a[252:255], v[88:91], v[176:191]
s_waitcnt lgkmcnt(6)
ds_read_b64_tr_b16 a[244:245], v1 offset:45440
ds_read_b64_tr_b16 a[246:247], v1 offset:45952
s_add_u32 s71, s71, s37
v_mfma_f32_32x32x16_bf16 v[128:143], a[224:227], v[92:95], v[128:143]
s_add_u32 m0, s43, 107328
ds_read_b64_tr_b16 a[248:249], v2 offset:45408
ds_read_b64_tr_b16 a[250:251], v2 offset:45920
buffer_load_dwordx4 v14, s[8:11], s46 offen lds
s_add_u32 s46, s46, 57344
s_sub_u32 s3, s46, 1605632
s_cmp_eq_u32 s3, s0
s_cselect_b32 s46, s0, s46
s_lshl_b32 s71, s71, 16
v_mfma_f32_32x32x16_bf16 v[144:159], a[228:231], v[92:95], v[144:159]
s_waitcnt lgkmcnt(6)
ds_read_b64_tr_b16 a[252:253], v2 offset:45440
ds_read_b64_tr_b16 a[254:255], v2 offset:45952
s_lshl_b32 s53, s52, 12
v_mfma_f32_32x32x16_bf16 v[160:175], a[232:235], v[92:95], v[160:175]
ds_read_b64_tr_b16 a[224:225], v1 offset:49536
ds_read_b64_tr_b16 a[226:227], v1 offset:50048
s_add_u32 s71, s71, s53
s_add_u32 s71, s71, s38
v_mfma_f32_32x32x16_bf16 v[176:191], a[236:239], v[92:95], v[176:191]
s_waitcnt lgkmcnt(6)
ds_read_b64_tr_b16 a[228:229], v1 offset:49568
ds_read_b64_tr_b16 a[230:231], v1 offset:50080
s_add_u32 s71, s71, 16777216
v_mfma_f32_32x32x16_bf16 v[128:143], a[240:243], v[96:99], v[128:143]
s_add_u32 m0, s43, 111456
ds_read_b64_tr_b16 a[232:233], v2 offset:49536
ds_read_b64_tr_b16 a[234:235], v2 offset:50048
buffer_load_dwordx4 v14, s[8:11], s46 offen lds
s_add_u32 s46, s46, 57344
s_lshl_b32 s39, s50, 1
v_mfma_f32_32x32x16_bf16 v[144:159], a[244:247], v[96:99], v[144:159]
s_waitcnt lgkmcnt(6)
ds_read_b64_tr_b16 a[236:237], v2 offset:49568
ds_read_b64_tr_b16 a[238:239], v2 offset:50080
s_add_u32 s39, s39, s37
v_mfma_f32_32x32x16_bf16 v[160:175], a[248:251], v[96:99], v[160:175]
ds_read_b64_tr_b16 a[240:241], v1 offset:53664
ds_read_b64_tr_b16 a[242:243], v1 offset:54176
s_mul_i32 s39, s39, 28672
v_mfma_f32_32x32x16_bf16 v[176:191], a[252:255], v[96:99], v[176:191]
s_waitcnt lgkmcnt(6)
ds_read_b64_tr_b16 a[244:245], v1 offset:53696
ds_read_b64_tr_b16 a[246:247], v1 offset:54208
s_lshl_b32 s38, s51, 7
s_add_u32 s39, s39, s38
v_mfma_f32_32x32x16_bf16 v[128:143], a[224:227], v[100:103], v[128:143]
s_add_u32 m0, s43, 115584
ds_read_b64_tr_b16 a[248:249], v2 offset:53664
ds_read_b64_tr_b16 a[250:251], v2 offset:54176
buffer_load_dwordx4 v14, s[8:11], s46 offen lds
s_add_u32 s46, s46, 57344
s_lshl_b32 s38, s36, 6
v_mfma_f32_32x32x16_bf16 v[144:159], a[228:231], v[100:103], v[144:159]
s_waitcnt lgkmcnt(6)
ds_read_b64_tr_b16 a[252:253], v2 offset:53696
ds_read_b64_tr_b16 a[254:255], v2 offset:54208
s_add_u32 s39, s39, s38
v_mfma_f32_32x32x16_bf16 v[160:175], a[232:235], v[100:103], v[160:175]
ds_read_b64_tr_b16 a[224:225], v1 offset:57792
ds_read_b64_tr_b16 a[226:227], v1 offset:58304
v_bfe_u32 v248, v0, 4, 5
s_waitcnt vmcnt(7)
v_readfirstlane_b32 s3, v9
s_cmp_eq_u32 s3, 255
s_cbranch_scc1 F_LAST
F_LAST_GO:
v_mfma_f32_32x32x16_bf16 v[176:191], a[236:239], v[100:103], v[176:191]
s_waitcnt lgkmcnt(6)
ds_read_b64_tr_b16 a[228:229], v1 offset:57824
ds_read_b64_tr_b16 a[230:231], v1 offset:58336
v_mul_u32_u24 v248, 896, v248
v_mfma_f32_32x32x16_bf16 v[128:143], a[240:243], v[104:107], v[128:143]
s_add_u32 m0, s43, 119712
ds_read_b64_tr_b16 a[232:233], v2 offset:57792
ds_read_b64_tr_b16 a[234:235], v2 offset:58304
buffer_load_dwordx4 v14, s[8:11], s46 offen lds
s_add_u32 s46, s46, 57344
v_add_u32 v248, s39, v248
v_lshrrev_b32 v250, 9, v0
v_mfma_f32_32x32x16_bf16 v[144:159], a[244:247], v[104:107], v[144:159]
s_waitcnt lgkmcnt(6)
ds_read_b64_tr_b16 a[236:237], v2 offset:57824
ds_read_b64_tr_b16 a[238:239], v2 offset:58336
v_lshl_add_u32 v249, v250, 4, v248
v_mfma_f32_32x32x16_bf16 v[160:175], a[248:251], v[104:107], v[160:175]
s_barrier
ds_read_b64_tr_b16 a[240:241], v3 offset:0
ds_read_b64_tr_b16 a[242:243], v3 offset:512
v_lshl_add_u32 v248, v250, 3, v248
v_mfma_f32_32x32x16_bf16 v[176:191], a[252:255], v[104:107], v[176:191]
s_waitcnt lgkmcnt(6)
ds_read_b64_tr_b16 a[244:245], v3 offset:32
ds_read_b64_tr_b16 a[246:247], v3 offset:544
v_mov_b32 v250, 0x5d800000
v_mfma_f32_32x32x16_bf16 v[128:143], a[224:227], v[108:111], v[128:143]
s_add_u32 m0, s43, 123840
ds_read_b64_tr_b16 a[248:249], v4 offset:0
ds_read_b64_tr_b16 a[250:251], v4 offset:512
buffer_load_dwordx4 v14, s[8:11], s46 offen lds
s_add_u32 s46, s46, 57344
s_sub_u32 s3, s46, 1605632
s_cmp_eq_u32 s3, s0
s_cselect_b32 s46, s0, s46
s_mov_b32 s53, 0x21800000
v_mfma_f32_32x32x16_bf16 v[144:159], a[228:231], v[108:111], v[144:159]
s_waitcnt lgkmcnt(6)
ds_read_b64_tr_b16 a[252:253], v4 offset:32
ds_read_b64_tr_b16 a[254:255], v4 offset:544
s_lshl_b32 s38, s40, 12
v_add_u32 v252, s38, v0
v_mfma_f32_32x32x16_bf16 v[160:175], a[232:235], v[108:111], v[160:175]
ds_read_b64_tr_b16 a[224:225], v3 offset:4128
ds_read_b64_tr_b16 a[226:227], v3 offset:4640
v_xor_b32 v251, 0x1000, v252
v_mfma_f32_32x32x16_bf16 v[176:191], a[236:239], v[108:111], v[176:191]
s_waitcnt lgkmcnt(6)
ds_read_b64_tr_b16 a[228:229], v3 offset:4160
ds_read_b64_tr_b16 a[230:231], v3 offset:4672
s_mul_i32 s36, s40, 12288
v_mfma_f32_32x32x16_bf16 v[128:143], a[240:243], v[112:115], v[128:143]
s_add_u32 m0, s43, 127968
ds_read_b64_tr_b16 a[232:233], v4 offset:4128
ds_read_b64_tr_b16 a[234:235], v4 offset:4640
buffer_load_dwordx4 v14, s[8:11], s46 offen lds
s_add_u32 s46, s46, 57344
v_add_u32 v247, s36, v0
v_mfma_f32_32x32x16_bf16 v[144:159], a[244:247], v[112:115], v[144:159]
s_waitcnt lgkmcnt(6)
ds_read_b64_tr_b16 a[236:237], v4 offset:4160
ds_read_b64_tr_b16 a[238:239], v4 offset:4672
s_mov_b32 s48, 1048576
v_mfma_f32_32x32x16_bf16 v[160:175], a[248:251], v[112:115], v[160:175]
ds_read_b64_tr_b16 a[240:241], v3 offset:8256
ds_read_b64_tr_b16 a[242:243], v3 offset:8768
s_xor_b32 s36, s40, 1
s_mul_i32 s36, s36, 12288
v_mfma_f32_32x32x16_bf16 v[176:191], a[252:255], v[112:115], v[176:191]
s_waitcnt lgkmcnt(6)
ds_read_b64_tr_b16 a[244:245], v3 offset:8288
ds_read_b64_tr_b16 a[246:247], v3 offset:8800
s_add_u32 s36, s36, 0
v_mfma_f32_32x32x16_bf16 v[128:143], a[224:227], v[116:119], v[128:143]
s_add_u32 m0, s43, 132096
ds_read_b64_tr_b16 a[248:249], v4 offset:8256
ds_read_b64_tr_b16 a[250:251], v4 offset:8768
buffer_load_dwordx4 v14, s[8:11], s46 offen lds
s_add_u32 s46, s46, 57344
v_add_u32 v244, s36, v0
v_mfma_f32_32x32x16_bf16 v[144:159], a[228:231], v[116:119], v[144:159]
s_waitcnt lgkmcnt(6)
ds_read_b64_tr_b16 a[252:253], v4 offset:8288
ds_read_b64_tr_b16 a[254:255], v4 offset:8800
s_xor_b32 s36, s40, 2
v_mfma_f32_32x32x16_bf16 v[160:175], a[232:235], v[116:119], v[160:175]
ds_read_b64_tr_b16 a[224:225], v3 offset:12384
ds_read_b64_tr_b16 a[226:227], v3 offset:12896
s_mul_i32 s36, s36, 12288
v_mfma_f32_32x32x16_bf16 v[176:191], a[236:239], v[116:119], v[176:191]
s_waitcnt lgkmcnt(6)
ds_read_b64_tr_b16 a[228:229], v3 offset:12416
ds_read_b64_tr_b16 a[230:231], v3 offset:12928
s_add_u32 s36, s36, 4096
v_add_u32 v245, s36, v0
v_mfma_f32_32x32x16_bf16 v[128:143], a[240:243], v[120:123], v[128:143]
s_add_u32 m0, s43, 136224
ds_read_b64_tr_b16 a[232:233], v4 offset:12384
ds_read_b64_tr_b16 a[234:235], v4 offset:12896
buffer_load_dwordx4 v14, s[8:11], s46 offen lds
s_add_u32 s46, s46, 57344
s_xor_b32 s36, s40, 3
v_mfma_f32_32x32x16_bf16 v[144:159], a[244:247], v[120:123], v[144:159]
s_waitcnt lgkmcnt(6)
ds_read_b64_tr_b16 a[236:237], v4 offset:12416
ds_read_b64_tr_b16 a[238:239], v4 offset:12928
s_mul_i32 s36, s36, 12288
v_mfma_f32_32x32x16_bf16 v[160:175], a[248:251], v[120:123], v[160:175]
s_waitcnt vmcnt(11)
s_barrier
ds_read_b64_tr_b16 a[240:241], v3 offset:16512
ds_read_b64_tr_b16 a[242:243], v3 offset:17024
s_add_u32 s36, s36, 8192
v_mfma_f32_32x32x16_bf16 v[176:191], a[252:255], v[120:123], v[176:191]
s_waitcnt lgkmcnt(6)
ds_read_b64_tr_b16 a[244:245], v3 offset:16544
ds_read_b64_tr_b16 a[246:247], v3 offset:17056
v_add_u32 v246, s36, v0
v_mfma_f32_32x32x16_bf16 v[128:143], a[224:227], v[124:127], v[128:143]
s_add_u32 m0, s43, 140352
ds_read_b64_tr_b16 a[248:249], v4 offset:16512
ds_read_b64_tr_b16 a[250:251], v4 offset:17024
buffer_load_dwordx4 v14, s[8:11], s46 offen lds
s_add_u32 s46, s46, 57344
s_sub_u32 s3, s46, 1605632
s_cmp_eq_u32 s3, s0
s_cselect_b32 s46, s0, s46
v_mfma_f32_32x32x16_bf16 v[144:159], a[228:231], v[124:127], v[144:159]
s_waitcnt lgkmcnt(6)
ds_read_b64_tr_b16 a[252:253], v3 offset:20640
ds_read_b64_tr_b16 a[254:255], v3 offset:21152
v_mfma_f32_32x32x16_bf16 v[160:175], a[232:235], v[124:127], v[160:175]
ds_read_b64_tr_b16 a[224:225], v3 offset:20672
ds_read_b64_tr_b16 a[226:227], v3 offset:21184
v_mfma_f32_32x32x16_bf16 v[176:191], a[236:239], v[124:127], v[176:191]
s_waitcnt lgkmcnt(6)
ds_read_b64_tr_b16 a[228:229], v4 offset:20640
ds_read_b64_tr_b16 a[230:231], v4 offset:21152
v_mfma_f32_32x32x16_bf16 v[192:207], a[240:243], v[16:19], 0
s_add_u32 m0, s43, 144480
ds_read_b64_tr_b16 a[232:233], v3 offset:24768
ds_read_b64_tr_b16 a[234:235], v3 offset:25280
buffer_load_dwordx4 v14, s[8:11], s46 offen lds
s_add_u32 s46, s46, 57344
v_mfma_f32_32x32x16_bf16 v[208:223], a[244:247], v[16:19], 0
s_waitcnt lgkmcnt(6)
ds_read_b64_tr_b16 a[236:237], v3 offset:24800
ds_read_b64_tr_b16 a[238:239], v3 offset:25312
v_mfma_f32_32x32x16_bf16 v[224:239], a[248:251], v[16:19], 0
ds_read_b64_tr_b16 a[240:241], v4 offset:24768
ds_read_b64_tr_b16 a[242:243], v4 offset:25280
v_mul_f32 v136, v128, v136
v_mul_f32 v137, v129, v137
v_mul_f32 v128, 0xbfb8aa3b, v128
v_mul_f32 v129, 0xbfb8aa3b, v129
v_mfma_f32_32x32x16_bf16 v[192:207], a[252:255], v[20:23], v[192:207]
s_add_u32 m0, s43, 148608
s_waitcnt lgkmcnt(6)
ds_read_b64_tr_b16 a[244:245], v3 offset:28896
ds_read_b64_tr_b16 a[246:247], v3 offset:29408
buffer_load_dwordx4 v14, s[8:11], s46 offen lds
s_add_u32 s46, s46, 57344
v_exp_f32 v128, v128
v_exp_f32 v129, v129
v_mfma_f32_32x32x16_bf16 v[208:223], a[224:227], v[20:23], v[208:223]
ds_read_b64_tr_b16 a[248:249], v3 offset:28928
ds_read_b64_tr_b16 a[250:251], v3 offset:29440
v_add_f32 v128, 1.0, v128
v_add_f32 v129, 1.0, v129
v_rcp_f32 v128, v128
v_mfma_f32_32x32x16_bf16 v[224:239], a[228:231], v[20:23], v[224:239]
s_waitcnt lgkmcnt(6)
ds_read_b64_tr_b16 a[252:253], v4 offset:28896
ds_read_b64_tr_b16 a[254:255], v4 offset:29408
v_rcp_f32 v129, v129
v_mul_f32 v136, v136, v128
v_mfma_f32_32x32x16_bf16 v[192:207], a[232:235], v[24:27], v[192:207]
s_add_u32 m0, s43, 0
s_waitcnt vmcnt(10)
s_barrier
ds_read_b64_tr_b16 a[224:225], v3 offset:33024
ds_read_b64_tr_b16 a[226:227], v3 offset:33536
buffer_load_dwordx4 v14, s[8:11], s46 offen lds
s_add_u32 s46, s46, 57344
v_mul_f32 v137, v137, v129
v_cvt_pk_bf16_f32 v128, v136, v137
v_mul_f32 v138, v130, v138
v_mul_f32 v139, v131, v139
v_mfma_f32_32x32x16_bf16 v[208:223], a[236:239], v[24:27], v[208:223]
s_waitcnt lgkmcnt(6)
ds_read_b64_tr_b16 a[228:229], v3 offset:33056
ds_read_b64_tr_b16 a[230:231], v3 offset:33568
v_mul_f32 v130, 0xbfb8aa3b, v130
v_mul_f32 v131, 0xbfb8aa3b, v131
v_exp_f32 v130, v130
v_mfma_f32_32x32x16_bf16 v[224:239], a[240:243], v[24:27], v[224:239]
ds_read_b64_tr_b16 a[232:233], v4 offset:33024
ds_read_b64_tr_b16 a[234:235], v4 offset:33536
v_exp_f32 v131, v131
v_add_f32 v130, 1.0, v130
v_mfma_f32_32x32x16_bf16 v[192:207], a[244:247], v[28:31], v[192:207]
s_add_u32 m0, s43, 4128
s_waitcnt lgkmcnt(6)
ds_read_b64_tr_b16 a[236:237], v3 offset:37152
ds_read_b64_tr_b16 a[238:239], v3 offset:37664
buffer_load_dwordx4 v14, s[8:11], s46 offen lds
s_add_u32 s46, s46, 57344
s_sub_u32 s3, s46, 1605632
s_cmp_eq_u32 s3, s0
s_cselect_b32 s46, s0, s46
v_add_f32 v131, 1.0, v131
v_rcp_f32 v130, v130
v_rcp_f32 v131, v131
v_mfma_f32_32x32x16_bf16 v[208:223], a[248:251], v[28:31], v[208:223]
ds_read_b64_tr_b16 a[240:241], v3 offset:37184
ds_read_b64_tr_b16 a[242:243], v3 offset:37696
v_mul_f32 v138, v138, v130
v_mul_f32 v139, v139, v131
v_cvt_pk_bf16_f32 v129, v138, v139
v_mfma_f32_32x32x16_bf16 v[224:239], a[252:255], v[28:31], v[224:239]
s_waitcnt lgkmcnt(6)
ds_read_b64_tr_b16 a[244:245], v4 offset:37152
ds_read_b64_tr_b16 a[246:247], v4 offset:37664
v_mul_f32 v140, v132, v140
v_mul_f32 v141, v133, v141
v_mul_f32 v132, 0xbfb8aa3b, v132
v_mul_f32 v133, 0xbfb8aa3b, v133
v_mfma_f32_32x32x16_bf16 v[192:207], a[224:227], v[32:35], v[192:207]
s_add_u32 m0, s43, 8256
ds_read_b64_tr_b16 a[248:249], v3 offset:41280
ds_read_b64_tr_b16 a[250:251], v3 offset:41792
buffer_load_dwordx4 v14, s[8:11], s46 offen lds
s_add_u32 s46, s46, 57344
v_exp_f32 v132, v132
v_exp_f32 v133, v133
v_mfma_f32_32x32x16_bf16 v[208:223], a[228:231], v[32:35], v[208:223]
s_waitcnt lgkmcnt(6)
ds_read_b64_tr_b16 a[252:253], v3 offset:41312
ds_read_b64_tr_b16 a[254:255], v3 offset:41824
v_add_f32 v132, 1.0, v132
v_add_f32 v133, 1.0, v133
v_rcp_f32 v132, v132
buffer_load_dword v9, v10, s[16:19], s58 offen sc1
v_mfma_f32_32x32x16_bf16 v[224:239], a[232:235], v[32:35], v[224:239]
ds_read_b64_tr_b16 a[224:225], v4 offset:41280
ds_read_b64_tr_b16 a[226:227], v4 offset:41792
v_rcp_f32 v133, v133
v_mul_f32 v140, v140, v132
v_mfma_f32_32x32x16_bf16 v[192:207], a[236:239], v[36:39], v[192:207]
s_add_u32 m0, s43, 12384
s_waitcnt lgkmcnt(6)
ds_read_b64_tr_b16 a[228:229], v3 offset:45408
ds_read_b64_tr_b16 a[230:231], v3 offset:45920
buffer_load_dwordx4 v14, s[8:11], s46 offen lds
s_add_u32 s46, s46, 57344
v_mul_f32 v141, v141, v133
v_cvt_pk_bf16_f32 v130, v140, v141
v_mul_f32 v142, v134, v142
v_mfma_f32_32x32x16_bf16 v[208:223], a[240:243], v[36:39], v[208:223]
ds_read_b64_tr_b16 a[232:233], v3 offset:45440
ds_read_b64_tr_b16 a[234:235], v3 offset:45952
v_mul_f32 v143, v135, v143
v_mul_f32 v134, 0xbfb8aa3b, v134
v_mul_f32 v135, 0xbfb8aa3b, v135
v_exp_f32 v134, v134
v_mfma_f32_32x32x16_bf16 v[224:239], a[244:247], v[36:39], v[224:239]
s_waitcnt lgkmcnt(6)
ds_read_b64_tr_b16 a[236:237], v4 offset:45408
ds_read_b64_tr_b16 a[238:239], v4 offset:45920
v_exp_f32 v135, v135
v_add_f32 v134, 1.0, v134
v_mfma_f32_32x32x16_bf16 v[192:207], a[248:251], v[40:43], v[192:207]
s_add_u32 m0, s43, 16512
s_waitcnt vmcnt(11)
s_barrier
ds_read_b64_tr_b16 a[240:241], v3 offset:49536
ds_read_b64_tr_b16 a[242:243], v3 offset:50048
buffer_load_dwordx4 v14, s[8:11], s46 offen lds
s_add_u32 s46, s46, 57344
v_add_f32 v135, 1.0, v135
v_rcp_f32 v134, v134
v_rcp_f32 v135, v135
v_mfma_f32_32x32x16_bf16 v[208:223], a[252:255], v[40:43], v[208:223]
s_waitcnt lgkmcnt(6)
ds_read_b64_tr_b16 a[244:245], v3 offset:49568
ds_read_b64_tr_b16 a[246:247], v3 offset:50080
v_mul_f32 v142, v142, v134
v_mul_f32 v143, v143, v135
v_mfma_f32_32x32x16_bf16 v[224:239], a[224:227], v[40:43], v[224:239]
ds_read_b64_tr_b16 a[248:249], v4 offset:49536
ds_read_b64_tr_b16 a[250:251], v4 offset:50048
v_cvt_pk_bf16_f32 v131, v142, v143
buffer_store_dwordx4 v[128:131], v0, s[16:19], s49 offen offset:0 sc1
v_mul_f32 v152, v144, v152
v_mul_f32 v153, v145, v153
v_mfma_f32_32x32x16_bf16 v[192:207], a[228:231], v[44:47], v[192:207]
s_add_u32 m0, s43, 20640
s_waitcnt lgkmcnt(6)
ds_read_b64_tr_b16 a[252:253], v3 offset:53664
ds_read_b64_tr_b16 a[254:255], v3 offset:54176
buffer_load_dwordx4 v14, s[8:11], s46 offen lds
s_add_u32 s46, s46, 57344
s_sub_u32 s3, s46, 1605632
s_cmp_eq_u32 s3, s0
s_cselect_b32 s46, s0, s46
v_mul_f32 v144, 0xbfb8aa3b, v144
v_mul_f32 v145, 0xbfb8aa3b, v145
v_exp_f32 v144, v144
v_mfma_f32_32x32x16_bf16 v[208:223], a[232:235], v[44:47], v[208:223]
ds_read_b64_tr_b16 a[224:225], v3 offset:53696
ds_read_b64_tr_b16 a[226:227], v3 offset:54208
v_exp_f32 v145, v145
v_add_f32 v144, 1.0, v144
v_mfma_f32_32x32x16_bf16 v[224:239], a[236:239], v[44:47], v[224:239]
s_waitcnt lgkmcnt(6)
ds_read_b64_tr_b16 a[228:229], v4 offset:53664
ds_read_b64_tr_b16 a[230:231], v4 offset:54176
v_add_f32 v145, 1.0, v145
v_rcp_f32 v144, v144
v_rcp_f32 v145, v145
v_mfma_f32_32x32x16_bf16 v[192:207], a[240:243], v[48:51], v[192:207]
s_add_u32 m0, s43, 24768
ds_read_b64_tr_b16 a[232:233], v3 offset:57792
ds_read_b64_tr_b16 a[234:235], v3 offset:58304
buffer_load_dwordx4 v14, s[8:11], s46 offen lds
s_add_u32 s46, s46, 57344
v_mul_f32 v152, v152, v144
v_mul_f32 v153, v153, v145
v_cvt_pk_bf16_f32 v144, v152, v153
v_mfma_f32_32x32x16_bf16 v[208:223], a[244:247], v[48:51], v[208:223]
s_waitcnt lgkmcnt(6)
ds_read_b64_tr_b16 a[236:237], v3 offset:57824
ds_read_b64_tr_b16 a[238:239], v3 offset:58336
v_mul_f32 v154, v146, v154
v_mul_f32 v155, v147, v155
v_mul_f32 v146, 0xbfb8aa3b, v146
v_mfma_f32_32x32x16_bf16 v[224:239], a[248:251], v[48:51], v[224:239]
ds_read_b64_tr_b16 a[240:241], v4 offset:57792
ds_read_b64_tr_b16 a[242:243], v4 offset:58304
v_mul_f32 v147, 0xbfb8aa3b, v147
v_exp_f32 v146, v146
v_exp_f32 v147, v147
v_mfma_f32_32x32x16_bf16 v[192:207], a[252:255], v[52:55], v[192:207]
s_add_u32 m0, s43, 28896
s_waitcnt lgkmcnt(6)
ds_read_b64_tr_b16 a[244:245], v5 offset:0
ds_read_b64_tr_b16 a[246:247], v5 offset:512
buffer_load_dwordx4 v14, s[8:11], s46 offen lds
s_add_u32 s46, s46, 57344
v_add_f32 v146, 1.0, v146
v_add_f32 v147, 1.0, v147
v_rcp_f32 v146, v146
v_mfma_f32_32x32x16_bf16 v[208:223], a[224:227], v[52:55], v[208:223]
ds_read_b64_tr_b16 a[248:249], v5 offset:32
ds_read_b64_tr_b16 a[250:251], v5 offset:544
v_rcp_f32 v147, v147
v_mul_f32 v154, v154, v146
v_mfma_f32_32x32x16_bf16 v[224:239], a[228:231], v[52:55], v[224:239]
s_waitcnt lgkmcnt(6)
ds_read_b64_tr_b16 a[252:253], v6 offset:0
ds_read_b64_tr_b16 a[254:255], v6 offset:512
v_mul_f32 v155, v155, v147
v_cvt_pk_bf16_f32 v145, v154, v155
v_mul_f32 v156, v148, v156
v_mfma_f32_32x32x16_bf16 v[192:207], a[232:235], v[56:59], v[192:207]
s_add_u32 m0, s43, 33024
s_waitcnt vmcnt(12)
s_barrier
ds_read_b64_tr_b16 a[224:225], v5 offset:4128
ds_read_b64_tr_b16 a[226:227], v5 offset:4640
buffer_load_dwordx4 v14, s[8:11], s46 offen lds
s_add_u32 s46, s46, 57344
v_mul_f32 v157, v149, v157
v_mul_f32 v148, 0xbfb8aa3b, v148
v_mul_f32 v149, 0xbfb8aa3b, v149
v_exp_f32 v148, v148
v_mfma_f32_32x32x16_bf16 v[208:223], a[236:239], v[56:59], v[208:223]
s_waitcnt lgkmcnt(6)
ds_read_b64_tr_b16 a[228:229], v5 offset:4160
ds_read_b64_tr_b16 a[230:231], v5 offset:4672
v_exp_f32 v149, v149
v_add_f32 v148, 1.0, v148
v_mfma_f32_32x32x16_bf16 v[224:239], a[240:243], v[56:59], v[224:239]
ds_read_b64_tr_b16 a[232:233], v6 offset:4128
ds_read_b64_tr_b16 a[234:235], v6 offset:4640
v_add_f32 v149, 1.0, v149
v_rcp_f32 v148, v148
v_mfma_f32_32x32x16_bf16 v[192:207], a[244:247], v[60:63], v[192:207]
s_add_u32 m0, s43, 37152
s_waitcnt lgkmcnt(6)
ds_read_b64_tr_b16 a[236:237], v5 offset:8256
ds_read_b64_tr_b16 a[238:239], v5 offset:8768
buffer_load_dwordx4 v14, s[8:11], s46 offen lds
v_rcp_f32 v149, v149
v_mul_f32 v156, v156, v148
v_mul_f32 v157, v157, v149
v_mfma_f32_32x32x16_bf16 v[208:223], a[248:251], v[60:63], v[208:223]
ds_read_b64_tr_b16 a[240:241], v5 offset:8288
ds_read_b64_tr_b16 a[242:243], v5 offset:8800
v_cvt_pk_bf16_f32 v146, v156, v157
v_mul_f32 v158, v150, v158
v_mul_f32 v159, v151, v159
v_mul_f32 v150, 0xbfb8aa3b, v150
v_mfma_f32_32x32x16_bf16 v[224:239], a[252:255], v[60:63], v[224:239]
s_waitcnt lgkmcnt(6)
ds_read_b64_tr_b16 a[244:245], v6 offset:8256
ds_read_b64_tr_b16 a[246:247], v6 offset:8768
v_mul_f32 v151, 0xbfb8aa3b, v151
v_exp_f32 v150, v150
v_exp_f32 v151, v151
v_mfma_f32_32x32x16_bf16 v[192:207], a[224:227], v[64:67], v[192:207]
ds_read_b64_tr_b16 a[248:249], v5 offset:12384
ds_read_b64_tr_b16 a[250:251], v5 offset:12896
v_add_f32 v150, 1.0, v150
v_add_f32 v151, 1.0, v151
s_waitcnt vmcnt(8)
v_cmp_ne_u32 vcc, 1, v9
s_cbranch_vccnz F_C_RT
F_C_GO:
v_mfma_f32_32x32x16_bf16 v[208:223], a[228:231], v[64:67], v[208:223]
s_waitcnt lgkmcnt(6)
ds_read_b64_tr_b16 a[252:253], v5 offset:12416
ds_read_b64_tr_b16 a[254:255], v5 offset:12928
v_rcp_f32 v150, v150
v_rcp_f32 v151, v151
buffer_load_dwordx4 v[16:19], v0, s[16:19], s56 offen offset:0 sc1
v_mfma_f32_32x32x16_bf16 v[224:239], a[232:235], v[64:67], v[224:239]
ds_read_b64_tr_b16 a[224:225], v6 offset:12384
ds_read_b64_tr_b16 a[226:227], v6 offset:12896
v_mul_f32 v158, v158, v150
v_mul_f32 v159, v159, v151
v_cvt_pk_bf16_f32 v147, v158, v159
buffer_store_dwordx4 v[144:147], v0, s[16:19], s49 offen offset:2048 sc1
buffer_load_dwordx4 v[20:23], v0, s[16:19], s56 offen offset:1024 sc1
v_mfma_f32_32x32x16_bf16 v[192:207], a[236:239], v[68:71], v[192:207]
s_waitcnt lgkmcnt(6)
ds_read_b64_tr_b16 a[228:229], v5 offset:16512
ds_read_b64_tr_b16 a[230:231], v5 offset:17024
s_add_u32 s49, s49, 4096
v_mul_f32 v168, v160, v168
v_mul_f32 v169, v161, v169
buffer_load_dwordx4 v[48:51], v0, s[16:19], s61 offen offset:0 sc1
v_mfma_f32_32x32x16_bf16 v[208:223], a[240:243], v[68:71], v[208:223]
ds_read_b64_tr_b16 a[232:233], v5 offset:16544
ds_read_b64_tr_b16 a[234:235], v5 offset:17056
v_mul_f32 v160, 0xbfb8aa3b, v160
v_mul_f32 v161, 0xbfb8aa3b, v161
v_exp_f32 v160, v160
buffer_load_dwordx4 v[52:55], v0, s[16:19], s61 offen offset:1024 sc1
v_mfma_f32_32x32x16_bf16 v[224:239], a[244:247], v[68:71], v[224:239]
s_waitcnt lgkmcnt(6)
ds_read_b64_tr_b16 a[236:237], v6 offset:16512
ds_read_b64_tr_b16 a[238:239], v6 offset:17024
v_exp_f32 v161, v161
v_add_f32 v160, 1.0, v160
v_add_f32 v161, 1.0, v161
buffer_load_dwordx4 v[24:27], v0, s[16:19], s57 offen offset:0 sc1
v_mfma_f32_32x32x16_bf16 v[192:207], a[248:251], v[72:75], v[192:207]
s_barrier
ds_read_b64_tr_b16 a[240:241], v5 offset:20640
ds_read_b64_tr_b16 a[242:243], v5 offset:21152
v_rcp_f32 v160, v160
v_rcp_f32 v161, v161
buffer_load_dwordx4 v[28:31], v0, s[16:19], s57 offen offset:1024 sc1
v_mfma_f32_32x32x16_bf16 v[208:223], a[252:255], v[72:75], v[208:223]
s_waitcnt lgkmcnt(6)
ds_read_b64_tr_b16 a[244:245], v5 offset:20672
ds_read_b64_tr_b16 a[246:247], v5 offset:21184
v_mul_f32 v168, v168, v160
v_mul_f32 v169, v169, v161
v_cvt_pk_bf16_f32 v160, v168, v169
buffer_load_dwordx4 v[56:59], v0, s[16:19], s61 offen offset:2048 sc1
v_mfma_f32_32x32x16_bf16 v[224:239], a[224:227], v[72:75], v[224:239]
ds_read_b64_tr_b16 a[248:249], v6 offset:20640
ds_read_b64_tr_b16 a[250:251], v6 offset:21152
v_mul_f32 v170, v162, v170
v_mul_f32 v171, v163, v171
v_mul_f32 v162, 0xbfb8aa3b, v162
v_mul_f32 v163, 0xbfb8aa3b, v163
buffer_load_dwordx4 v[60:63], v0, s[16:19], s61 offen offset:3072 sc1
s_add_u32 s61, s61, 4096
v_mfma_f32_32x32x16_bf16 v[192:207], a[228:231], v[76:79], v[192:207]
s_waitcnt lgkmcnt(6)
ds_read_b64_tr_b16 a[252:253], v5 offset:24768
ds_read_b64_tr_b16 a[254:255], v5 offset:25280
v_exp_f32 v162, v162
v_exp_f32 v163, v163
buffer_load_dwordx4 v[32:35], v0, s[16:19], s41 offen offset:0 sc1
v_mfma_f32_32x32x16_bf16 v[208:223], a[232:235], v[76:79], v[208:223]
ds_read_b64_tr_b16 a[224:225], v5 offset:24800
ds_read_b64_tr_b16 a[226:227], v5 offset:25312
v_add_f32 v162, 1.0, v162
v_add_f32 v163, 1.0, v163
v_rcp_f32 v162, v162
buffer_load_dwordx4 v[36:39], v0, s[16:19], s41 offen offset:1024 sc1
v_mfma_f32_32x32x16_bf16 v[224:239], a[236:239], v[76:79], v[224:239]
s_waitcnt lgkmcnt(6)
ds_read_b64_tr_b16 a[228:229], v6 offset:24768
ds_read_b64_tr_b16 a[230:231], v6 offset:25280
v_rcp_f32 v163, v163
v_mul_f32 v170, v170, v162
buffer_load_dwordx4 v[40:43], v0, s[16:19], s42 offen offset:0 sc1
v_mfma_f32_32x32x16_bf16 v[192:207], a[240:243], v[80:83], v[192:207]
ds_read_b64_tr_b16 a[232:233], v1 offset:0
ds_read_b64_tr_b16 a[234:235], v1 offset:512
v_mul_f32 v171, v171, v163
v_cvt_pk_bf16_f32 v161, v170, v171
v_mul_f32 v172, v164, v172
v_mul_f32 v173, v165, v173
buffer_load_dwordx4 v[44:47], v0, s[16:19], s42 offen offset:1024 sc1
v_mfma_f32_32x32x16_bf16 v[208:223], a[244:247], v[80:83], v[208:223]
s_waitcnt lgkmcnt(6)
ds_read_b64_tr_b16 a[236:237], v1 offset:32
ds_read_b64_tr_b16 a[238:239], v1 offset:544
v_mul_f32 v164, 0xbfb8aa3b, v164
v_mul_f32 v165, 0xbfb8aa3b, v165
v_exp_f32 v164, v164
buffer_load_dwordx4 v[64:67], v0, s[16:19], s61 offen offset:0 sc1
v_mfma_f32_32x32x16_bf16 v[224:239], a[248:251], v[80:83], v[224:239]
ds_read_b64_tr_b16 a[240:241], v2 offset:0
ds_read_b64_tr_b16 a[242:243], v2 offset:512
v_exp_f32 v165, v165
v_add_f32 v164, 1.0, v164
buffer_load_dwordx4 v[68:71], v0, s[16:19], s61 offen offset:1024 sc1
v_mfma_f32_32x32x16_bf16 v[192:207], a[252:255], v[84:87], v[192:207]
s_waitcnt lgkmcnt(6)
ds_read_b64_tr_b16 a[244:245], v1 offset:4128
ds_read_b64_tr_b16 a[246:247], v1 offset:4640
v_add_f32 v165, 1.0, v165
v_rcp_f32 v164, v164
v_rcp_f32 v165, v165
buffer_load_dwordx4 v[72:75], v0, s[16:19], s61 offen offset:2048 sc1
v_mfma_f32_32x32x16_bf16 v[208:223], a[224:227], v[84:87], v[208:223]
ds_read_b64_tr_b16 a[248:249], v1 offset:4160
ds_read_b64_tr_b16 a[250:251], v1 offset:4672
v_mul_f32 v172, v172, v164
v_mul_f32 v173, v173, v165
v_cvt_pk_bf16_f32 v162, v172, v173
buffer_load_dwordx4 v[76:79], v0, s[16:19], s61 offen offset:3072 sc1
s_add_u32 s61, s61, 4096
v_mfma_f32_32x32x16_bf16 v[224:239], a[228:231], v[84:87], v[224:239]
s_waitcnt lgkmcnt(6)
ds_read_b64_tr_b16 a[252:253], v2 offset:4128
ds_read_b64_tr_b16 a[254:255], v2 offset:4640
v_mul_f32 v174, v166, v174
v_mul_f32 v175, v167, v175
v_mul_f32 v166, 0xbfb8aa3b, v166
v_mfma_f32_32x32x16_bf16 v[192:207], a[232:235], v[88:91], v[192:207]
s_waitcnt vmcnt(21)
s_barrier
ds_read_b64_tr_b16 a[224:225], v1 offset:8256
ds_read_b64_tr_b16 a[226:227], v1 offset:8768
v_mul_f32 v167, 0xbfb8aa3b, v167
v_exp_f32 v166, v166
v_exp_f32 v167, v167
v_mfma_f32_32x32x16_bf16 v[208:223], a[236:239], v[88:91], v[208:223]
s_waitcnt lgkmcnt(6)
ds_read_b64_tr_b16 a[228:229], v1 offset:8288
ds_read_b64_tr_b16 a[230:231], v1 offset:8800
v_add_f32 v166, 1.0, v166
v_add_f32 v167, 1.0, v167
v_rcp_f32 v166, v166
v_mfma_f32_32x32x16_bf16 v[224:239], a[240:243], v[88:91], v[224:239]
ds_read_b64_tr_b16 a[232:233], v2 offset:8256
ds_read_b64_tr_b16 a[234:235], v2 offset:8768
v_rcp_f32 v167, v167
v_mfma_f32_32x32x16_bf16 v[192:207], a[244:247], v[92:95], v[192:207]
s_waitcnt lgkmcnt(6)
ds_read_b64_tr_b16 a[236:237], v1 offset:12384
ds_read_b64_tr_b16 a[238:239], v1 offset:12896
v_mul_f32 v174, v174, v166
v_mul_f32 v175, v175, v167
v_cvt_pk_bf16_f32 v163, v174, v175
buffer_store_dwordx4 v[160:163], v0, s[16:19], s49 offen offset:0 sc1
v_mfma_f32_32x32x16_bf16 v[208:223], a[248:251], v[92:95], v[208:223]
ds_read_b64_tr_b16 a[240:241], v1 offset:12416
ds_read_b64_tr_b16 a[242:243], v1 offset:12928
v_mul_f32 v184, v176, v184
v_mul_f32 v185, v177, v185
v_mul_f32 v176, 0xbfb8aa3b, v176
v_mul_f32 v177, 0xbfb8aa3b, v177
v_mfma_f32_32x32x16_bf16 v[224:239], a[252:255], v[92:95], v[224:239]
s_waitcnt lgkmcnt(6)
ds_read_b64_tr_b16 a[244:245], v2 offset:12384
ds_read_b64_tr_b16 a[246:247], v2 offset:12896
v_exp_f32 v176, v176
v_exp_f32 v177, v177
v_mfma_f32_32x32x16_bf16 v[192:207], a[224:227], v[96:99], v[192:207]
ds_read_b64_tr_b16 a[248:249], v1 offset:16512
ds_read_b64_tr_b16 a[250:251], v1 offset:17024
v_add_f32 v176, 1.0, v176
v_add_f32 v177, 1.0, v177
v_rcp_f32 v176, v176
buffer_load_dwordx4 v[80:83], v0, s[16:19], s61 offen offset:0 sc1
v_mfma_f32_32x32x16_bf16 v[208:223], a[228:231], v[96:99], v[208:223]
s_waitcnt lgkmcnt(6)
ds_read_b64_tr_b16 a[252:253], v1 offset:16544
ds_read_b64_tr_b16 a[254:255], v1 offset:17056
v_rcp_f32 v177, v177
v_mul_f32 v184, v184, v176
buffer_load_dwordx4 v[84:87], v0, s[16:19], s61 offen offset:1024 sc1
v_mfma_f32_32x32x16_bf16 v[224:239], a[232:235], v[96:99], v[224:239]
ds_read_b64_tr_b16 a[224:225], v2 offset:16512
ds_read_b64_tr_b16 a[226:227], v2 offset:17024
v_mul_f32 v185, v185, v177
v_cvt_pk_bf16_f32 v176, v184, v185
v_mul_f32 v186, v178, v186
v_mul_f32 v187, v179, v187
buffer_load_dwordx4 v[88:91], v0, s[16:19], s61 offen offset:2048 sc1
v_mfma_f32_32x32x16_bf16 v[192:207], a[236:239], v[100:103], v[192:207]
s_waitcnt lgkmcnt(6)
ds_read_b64_tr_b16 a[228:229], v1 offset:20640
ds_read_b64_tr_b16 a[230:231], v1 offset:21152
v_mul_f32 v178, 0xbfb8aa3b, v178
v_mul_f32 v179, 0xbfb8aa3b, v179
v_exp_f32 v178, v178
buffer_load_dwordx4 v[92:95], v0, s[16:19], s61 offen offset:3072 sc1
s_add_u32 s61, s61, 4096
v_mfma_f32_32x32x16_bf16 v[208:223], a[240:243], v[100:103], v[208:223]
ds_read_b64_tr_b16 a[232:233], v1 offset:20672
ds_read_b64_tr_b16 a[234:235], v1 offset:21184
v_exp_f32 v179, v179
v_add_f32 v178, 1.0, v178
v_mfma_f32_32x32x16_bf16 v[224:239], a[244:247], v[100:103], v[224:239]
s_waitcnt lgkmcnt(6)
ds_read_b64_tr_b16 a[236:237], v2 offset:20640
ds_read_b64_tr_b16 a[238:239], v2 offset:21152
v_add_f32 v179, 1.0, v179
v_rcp_f32 v178, v178
v_rcp_f32 v179, v179
v_mfma_f32_32x32x16_bf16 v[192:207], a[248:251], v[104:107], v[192:207]
s_waitcnt vmcnt(22)
s_barrier
ds_read_b64_tr_b16 a[240:241], v1 offset:24768
ds_read_b64_tr_b16 a[242:243], v1 offset:25280
v_mul_f32 v186, v186, v178
v_mul_f32 v187, v187, v179
v_mfma_f32_32x32x16_bf16 v[208:223], a[252:255], v[104:107], v[208:223]
s_waitcnt lgkmcnt(6)
ds_read_b64_tr_b16 a[244:245], v1 offset:24800
ds_read_b64_tr_b16 a[246:247], v1 offset:25312
v_cvt_pk_bf16_f32 v177, v186, v187
v_mul_f32 v188, v180, v188
v_mul_f32 v189, v181, v189
v_mul_f32 v180, 0xbfb8aa3b, v180
v_mfma_f32_32x32x16_bf16 v[224:239], a[224:227], v[104:107], v[224:239]
ds_read_b64_tr_b16 a[248:249], v2 offset:24768
ds_read_b64_tr_b16 a[250:251], v2 offset:25280
v_mul_f32 v181, 0xbfb8aa3b, v181
v_exp_f32 v180, v180
v_exp_f32 v181, v181
v_mfma_f32_32x32x16_bf16 v[192:207], a[228:231], v[108:111], v[192:207]
s_waitcnt lgkmcnt(6)
ds_read_b64_tr_b16 a[252:253], v1 offset:28896
ds_read_b64_tr_b16 a[254:255], v1 offset:29408
v_add_f32 v180, 1.0, v180
v_add_f32 v181, 1.0, v181
v_rcp_f32 v180, v180
v_mfma_f32_32x32x16_bf16 v[208:223], a[232:235], v[108:111], v[208:223]
ds_read_b64_tr_b16 a[224:225], v1 offset:28928
ds_read_b64_tr_b16 a[226:227], v1 offset:29440
v_rcp_f32 v181, v181
v_mfma_f32_32x32x16_bf16 v[224:239], a[236:239], v[108:111], v[224:239]
s_waitcnt lgkmcnt(6)
ds_read_b64_tr_b16 a[228:229], v2 offset:28896
ds_read_b64_tr_b16 a[230:231], v2 offset:29408
v_mul_f32 v188, v188, v180
v_mul_f32 v189, v189, v181
v_cvt_pk_bf16_f32 v178, v188, v189
v_mul_f32 v190, v182, v190
v_mfma_f32_32x32x16_bf16 v[192:207], a[240:243], v[112:115], v[192:207]
ds_read_b64_tr_b16 a[232:233], v1 offset:33024
ds_read_b64_tr_b16 a[234:235], v1 offset:33536
v_mul_f32 v191, v183, v191
v_mul_f32 v182, 0xbfb8aa3b, v182
v_mul_f32 v183, 0xbfb8aa3b, v183
v_exp_f32 v182, v182
v_mfma_f32_32x32x16_bf16 v[208:223], a[244:247], v[112:115], v[208:223]
s_waitcnt lgkmcnt(6)
ds_read_b64_tr_b16 a[236:237], v1 offset:33056
ds_read_b64_tr_b16 a[238:239], v1 offset:33568
v_exp_f32 v183, v183
v_mfma_f32_32x32x16_bf16 v[224:239], a[248:251], v[112:115], v[224:239]
ds_read_b64_tr_b16 a[240:241], v2 offset:33024
ds_read_b64_tr_b16 a[242:243], v2 offset:33536
v_add_f32 v182, 1.0, v182
v_add_f32 v183, 1.0, v183
v_rcp_f32 v182, v182
v_mfma_f32_32x32x16_bf16 v[192:207], a[252:255], v[116:119], v[192:207]
s_waitcnt lgkmcnt(6)
ds_read_b64_tr_b16 a[244:245], v1 offset:37152
ds_read_b64_tr_b16 a[246:247], v1 offset:37664
v_rcp_f32 v183, v183
v_mul_f32 v190, v190, v182
v_mul_f32 v191, v191, v183
v_mfma_f32_32x32x16_bf16 v[208:223], a[224:227], v[116:119], v[208:223]
ds_read_b64_tr_b16 a[248:249], v1 offset:37184
ds_read_b64_tr_b16 a[250:251], v1 offset:37696
v_cvt_pk_bf16_f32 v179, v190, v191
buffer_store_dwordx4 v[176:179], v0, s[16:19], s49 offen offset:2048 sc1
s_add_u32 s49, s49, 4096
v_mfma_f32_32x32x16_bf16 v[224:239], a[228:231], v[116:119], v[224:239]
s_waitcnt lgkmcnt(6)
ds_read_b64_tr_b16 a[252:253], v2 offset:37152
ds_read_b64_tr_b16 a[254:255], v2 offset:37664
v_mfma_f32_32x32x16_bf16 v[192:207], a[232:235], v[120:123], v[192:207]
v_mfma_f32_32x32x16_bf16 v[208:223], a[236:239], v[120:123], v[208:223]
s_waitcnt lgkmcnt(4)
v_mfma_f32_32x32x16_bf16 v[224:239], a[240:243], v[120:123], v[224:239]
v_mfma_f32_32x32x16_bf16 v[192:207], a[244:247], v[124:127], v[192:207]
s_waitcnt lgkmcnt(0)
v_mfma_f32_32x32x16_bf16 v[208:223], a[248:251], v[124:127], v[208:223]
v_mfma_f32_32x32x16_bf16 v[224:239], a[252:255], v[124:127], v[224:239]
s_waitcnt vmcnt(19)
v_mfma_f32_32x32x16_bf16 v[128:143], v[48:51], v[16:19], 0
s_waitcnt vmcnt(18)
v_mfma_f32_32x32x16_bf16 v[128:143], v[52:55], v[20:23], v[128:143]
v_add_u32 v1, 4096, v0
v_add_u32 v2, 8192, v0
v_add_u32 v3, 12288, v0
s_nop 1
v_mul_f32 v200, v192, v200
v_mul_f32 v201, v193, v201
v_mul_f32 v192, 0xbfb8aa3b, v192
v_mul_f32 v193, 0xbfb8aa3b, v193
v_exp_f32 v192, v192
v_exp_f32 v193, v193
v_add_f32 v192, 1.0, v192
v_add_f32 v193, 1.0, v193
v_rcp_f32 v192, v192
buffer_load_dwordx4 a[128:131], v240, s[24:27], s65 offen offset:0 sc1
v_rcp_f32 v193, v193
v_mul_f32 v200, v200, v192
v_mul_f32 v201, v201, v193
v_cvt_pk_bf16_f32 v192, v200, v201
v_mul_f32 v202, v194, v202
v_mul_f32 v203, v195, v203
v_mul_f32 v194, 0xbfb8aa3b, v194
v_mul_f32 v195, 0xbfb8aa3b, v195
v_exp_f32 v194, v194
buffer_load_dwordx4 a[132:135], v241, s[24:27], s65 offen offset:0 sc1
v_exp_f32 v195, v195
v_add_f32 v194, 1.0, v194
v_add_f32 v195, 1.0, v195
v_rcp_f32 v194, v194
v_rcp_f32 v195, v195
v_mul_f32 v202, v202, v194
v_mul_f32 v203, v203, v195
v_cvt_pk_bf16_f32 v193, v202, v203
v_mul_f32 v204, v196, v204
buffer_load_dwordx4 a[144:147], v240, s[24:27], s65 offen offset:2048 sc1
v_mul_f32 v205, v197, v205
v_mul_f32 v196, 0xbfb8aa3b, v196
v_mul_f32 v197, 0xbfb8aa3b, v197
v_exp_f32 v196, v196
v_exp_f32 v197, v197
v_add_f32 v196, 1.0, v196
v_add_f32 v197, 1.0, v197
v_rcp_f32 v196, v196
v_rcp_f32 v197, v197
buffer_load_dwordx4 a[148:151], v241, s[24:27], s65 offen offset:2048 sc1
s_add_u32 s65, s65, 4096
v_mul_f32 v204, v204, v196
v_mul_f32 v205, v205, v197
v_cvt_pk_bf16_f32 v194, v204, v205
v_mul_f32 v206, v198, v206
v_mul_f32 v207, v199, v207
v_mul_f32 v198, 0xbfb8aa3b, v198
v_mul_f32 v199, 0xbfb8aa3b, v199
v_exp_f32 v198, v198
v_exp_f32 v199, v199
buffer_load_dwordx4 a[160:163], v240, s[24:27], s65 offen offset:0 sc1
v_add_f32 v198, 1.0, v198
v_add_f32 v199, 1.0, v199
v_rcp_f32 v198, v198
v_rcp_f32 v199, v199
v_mul_f32 v206, v206, v198
v_mul_f32 v207, v207, v199
v_cvt_pk_bf16_f32 v195, v206, v207
buffer_store_dwordx4 v[192:195], v0, s[16:19], s49 offen offset:0 sc1
v_mul_f32 v216, v208, v216
buffer_load_dwordx4 a[164:167], v241, s[24:27], s65 offen offset:0 sc1
v_mul_f32 v217, v209, v217
v_mul_f32 v208, 0xbfb8aa3b, v208
v_mul_f32 v209, 0xbfb8aa3b, v209
v_exp_f32 v208, v208
v_exp_f32 v209, v209
v_add_f32 v208, 1.0, v208
v_add_f32 v209, 1.0, v209
v_rcp_f32 v208, v208
v_rcp_f32 v209, v209
buffer_load_dwordx4 a[176:179], v240, s[24:27], s65 offen offset:2048 sc1
v_mul_f32 v216, v216, v208
v_mul_f32 v217, v217, v209
v_cvt_pk_bf16_f32 v208, v216, v217
v_mul_f32 v218, v210, v218
v_mul_f32 v219, v211, v219
v_mul_f32 v210, 0xbfb8aa3b, v210
v_mul_f32 v211, 0xbfb8aa3b, v211
v_exp_f32 v210, v210
v_exp_f32 v211, v211
buffer_load_dwordx4 a[180:183], v241, s[24:27], s65 offen offset:2048 sc1
s_add_u32 s65, s65, 4096
v_add_f32 v210, 1.0, v210
v_add_f32 v211, 1.0, v211
v_rcp_f32 v210, v210
v_rcp_f32 v211, v211
v_mul_f32 v218, v218, v210
v_mul_f32 v219, v219, v211
v_cvt_pk_bf16_f32 v209, v218, v219
v_mul_f32 v220, v212, v220
v_mul_f32 v221, v213, v221
buffer_load_dwordx4 a[192:195], v240, s[24:27], s65 offen offset:0 sc1
v_mul_f32 v212, 0xbfb8aa3b, v212
v_mul_f32 v213, 0xbfb8aa3b, v213
v_exp_f32 v212, v212
v_exp_f32 v213, v213
v_add_f32 v212, 1.0, v212
v_add_f32 v213, 1.0, v213
v_rcp_f32 v212, v212
v_rcp_f32 v213, v213
v_mul_f32 v220, v220, v212
buffer_load_dwordx4 a[196:199], v241, s[24:27], s65 offen offset:0 sc1
v_mul_f32 v221, v221, v213
v_cvt_pk_bf16_f32 v210, v220, v221
v_mul_f32 v222, v214, v222
v_mul_f32 v223, v215, v223
v_mul_f32 v214, 0xbfb8aa3b, v214
v_mul_f32 v215, 0xbfb8aa3b, v215
v_exp_f32 v214, v214
v_exp_f32 v215, v215
v_add_f32 v214, 1.0, v214
buffer_load_dwordx4 a[208:211], v240, s[24:27], s65 offen offset:2048 sc1
v_add_f32 v215, 1.0, v215
v_rcp_f32 v214, v214
v_rcp_f32 v215, v215
v_mul_f32 v222, v222, v214
v_mul_f32 v223, v223, v215
v_cvt_pk_bf16_f32 v211, v222, v223
buffer_store_dwordx4 v[208:211], v0, s[16:19], s49 offen offset:2048 sc1
s_add_u32 s49, s49, 4096
v_mul_f32 v232, v224, v232
buffer_load_dwordx4 a[212:215], v241, s[24:27], s65 offen offset:2048 sc1
s_add_u32 s65, s65, 4096
v_mul_f32 v233, v225, v233
v_mul_f32 v224, 0xbfb8aa3b, v224
v_mul_f32 v225, 0xbfb8aa3b, v225
v_exp_f32 v224, v224
v_exp_f32 v225, v225
v_add_f32 v224, 1.0, v224
v_add_f32 v225, 1.0, v225
v_rcp_f32 v224, v224
v_rcp_f32 v225, v225
buffer_load_dwordx4 a[224:227], v240, s[24:27], s65 offen offset:0 sc1
v_mul_f32 v232, v232, v224
v_mul_f32 v233, v233, v225
v_cvt_pk_bf16_f32 v224, v232, v233
v_mul_f32 v234, v226, v234
v_mul_f32 v235, v227, v235
v_mul_f32 v226, 0xbfb8aa3b, v226
v_mul_f32 v227, 0xbfb8aa3b, v227
v_exp_f32 v226, v226
v_exp_f32 v227, v227
buffer_load_dwordx4 a[228:231], v241, s[24:27], s65 offen offset:0 sc1
v_add_f32 v226, 1.0, v226
v_add_f32 v227, 1.0, v227
v_rcp_f32 v226, v226
v_rcp_f32 v227, v227
v_mul_f32 v234, v234, v226
v_mul_f32 v235, v235, v227
v_cvt_pk_bf16_f32 v225, v234, v235
v_mul_f32 v236, v228, v236
v_mul_f32 v237, v229, v237
buffer_load_dwordx4 a[240:243], v240, s[24:27], s65 offen offset:2048 sc1
v_mul_f32 v228, 0xbfb8aa3b, v228
v_mul_f32 v229, 0xbfb8aa3b, v229
v_exp_f32 v228, v228
v_exp_f32 v229, v229
v_add_f32 v228, 1.0, v228
v_add_f32 v229, 1.0, v229
v_rcp_f32 v228, v228
v_rcp_f32 v229, v229
v_mul_f32 v236, v236, v228
buffer_load_dwordx4 a[244:247], v241, s[24:27], s65 offen offset:2048 sc1
s_add_u32 s65, s65, 4096
v_mul_f32 v237, v237, v229
v_cvt_pk_bf16_f32 v226, v236, v237
v_mul_f32 v238, v230, v238
v_mul_f32 v239, v231, v239
v_mul_f32 v230, 0xbfb8aa3b, v230
v_mul_f32 v231, 0xbfb8aa3b, v231
v_exp_f32 v230, v230
v_exp_f32 v231, v231
v_add_f32 v230, 1.0, v230
v_add_f32 v231, 1.0, v231
v_rcp_f32 v230, v230
v_rcp_f32 v231, v231
v_mul_f32 v238, v238, v230
v_mul_f32 v239, v239, v231
v_cvt_pk_bf16_f32 v227, v238, v239
buffer_store_dwordx4 v[224:227], v0, s[16:19], s49 offen offset:0 sc1
v_exp_f32 v128, v128
v_exp_f32 v129, v129
v_exp_f32 v130, v130
s_waitcnt vmcnt(33)
v_cvt_pk_bf16_f32 v112, v128, v129
v_exp_f32 v131, v131
v_exp_f32 v132, v132
v_cvt_pk_bf16_f32 v113, v130, v131
v_mfma_f32_32x32x16_bf16 v[144:159], v[48:51], v[24:27], 0
buffer_load_dwordx4 v[96:99], v0, s[16:19], s61 offen offset:0 sc1
v_exp_f32 v133, v133
v_exp_f32 v134, v134
v_cvt_pk_bf16_f32 v114, v132, v133
v_exp_f32 v135, v135
v_mfma_f32_32x32x16_bf16 v[144:159], v[52:55], v[28:31], v[144:159]
v_exp_f32 v136, v136
v_cvt_pk_bf16_f32 v115, v134, v135
v_exp_f32 v137, v137
v_exp_f32 v138, v138
v_cvt_pk_bf16_f32 v116, v136, v137
v_mfma_f32_32x32x16_bf16 a[0:15], v[56:59], v[112:115], 0
v_exp_f32 v139, v139
v_exp_f32 v140, v140
v_cvt_pk_bf16_f32 v117, v138, v139
v_exp_f32 v141, v141
v_exp_f32 v142, v142
v_cvt_pk_bf16_f32 v118, v140, v141
v_exp_f32 v143, v143
v_exp_f32 v144, v144
v_cvt_pk_bf16_f32 v119, v142, v143
v_exp_f32 v145, v145
v_exp_f32 v146, v146
v_mfma_f32_32x32x16_bf16 a[0:15], v[60:63], v[116:119], a[0:15]
v_cvt_pk_bf16_f32 v112, v144, v145
v_exp_f32 v147, v147
v_exp_f32 v148, v148
v_cvt_pk_bf16_f32 v113, v146, v147
s_waitcnt vmcnt(33)
v_mfma_f32_32x32x16_bf16 v[128:143], v[48:51], v[32:35], 0
buffer_load_dwordx4 v[100:103], v0, s[16:19], s61 offen offset:1024 sc1
s_add_u32 m0, s68, 0
v_exp_f32 v149, v149
v_exp_f32 v150, v150
v_cvt_pk_bf16_f32 v114, v148, v149
v_exp_f32 v151, v151
s_waitcnt vmcnt(33)
v_mfma_f32_32x32x16_bf16 v[128:143], v[52:55], v[36:39], v[128:143]
buffer_load_dwordx4 v0, s[16:19], s67 offen offset:0 sc1 lds
v_exp_f32 v152, v152
v_cvt_pk_bf16_f32 v115, v150, v151
v_exp_f32 v153, v153
v_exp_f32 v154, v154
v_cvt_pk_bf16_f32 v116, v152, v153
v_mfma_f32_32x32x16_bf16 a[16:31], v[56:59], v[112:115], 0
v_exp_f32 v155, v155
v_exp_f32 v156, v156
v_cvt_pk_bf16_f32 v117, v154, v155
v_exp_f32 v157, v157
v_exp_f32 v158, v158
v_cvt_pk_bf16_f32 v118, v156, v157
v_exp_f32 v159, v159
v_exp_f32 v128, v128
v_cvt_pk_bf16_f32 v119, v158, v159
v_exp_f32 v129, v129
v_exp_f32 v130, v130
v_mfma_f32_32x32x16_bf16 a[16:31], v[60:63], v[116:119], a[16:31]
v_cvt_pk_bf16_f32 v112, v128, v129
v_exp_f32 v131, v131
v_exp_f32 v132, v132
v_cvt_pk_bf16_f32 v113, v130, v131
s_waitcnt vmcnt(33)
v_mfma_f32_32x32x16_bf16 v[144:159], v[48:51], v[40:43], 0
buffer_load_dwordx4 v[104:107], v0, s[16:19], s61 offen offset:2048 sc1
v_exp_f32 v133, v133
v_exp_f32 v134, v134
v_cvt_pk_bf16_f32 v114, v132, v133
v_exp_f32 v135, v135
s_waitcnt vmcnt(33)
v_mfma_f32_32x32x16_bf16 v[144:159], v[52:55], v[44:47], v[144:159]
buffer_load_dwordx4 v0, s[16:19], s67 offen offset:1024 sc1 lds
v_exp_f32 v136, v136
v_cvt_pk_bf16_f32 v115, v134, v135
v_exp_f32 v137, v137
v_exp_f32 v138, v138
v_cvt_pk_bf16_f32 v116, v136, v137
v_mfma_f32_32x32x16_bf16 a[32:47], v[56:59], v[112:115], 0
v_exp_f32 v139, v139
v_exp_f32 v140, v140
v_cvt_pk_bf16_f32 v117, v138, v139
v_exp_f32 v141, v141
v_exp_f32 v142, v142
v_cvt_pk_bf16_f32 v118, v140, v141
v_exp_f32 v143, v143
v_exp_f32 v144, v144
v_cvt_pk_bf16_f32 v119, v142, v143
v_exp_f32 v145, v145
v_exp_f32 v146, v146
v_mfma_f32_32x32x16_bf16 a[32:47], v[60:63], v[116:119], a[32:47]
s_waitcnt vmcnt(32)
v_cvt_pk_bf16_f32 v112, v144, v145
v_exp_f32 v147, v147
v_exp_f32 v148, v148
v_cvt_pk_bf16_f32 v113, v146, v147
v_mfma_f32_32x32x16_bf16 v[128:143], v[64:67], v[16:19], 0
buffer_load_dwordx4 v[108:111], v0, s[16:19], s61 offen offset:3072 sc1
s_add_u32 s61, s61, 4096
v_exp_f32 v149, v149
v_exp_f32 v150, v150
v_cvt_pk_bf16_f32 v114, v148, v149
v_exp_f32 v151, v151
v_mfma_f32_32x32x16_bf16 v[128:143], v[68:71], v[20:23], v[128:143]
buffer_load_dwordx4 v0, s[16:19], s67 offen offset:2048 sc1 lds
v_exp_f32 v152, v152
v_cvt_pk_bf16_f32 v115, v150, v151
v_exp_f32 v153, v153
v_exp_f32 v154, v154
v_cvt_pk_bf16_f32 v116, v152, v153
v_mfma_f32_32x32x16_bf16 a[48:63], v[56:59], v[112:115], 0
v_exp_f32 v155, v155
v_exp_f32 v156, v156
v_cvt_pk_bf16_f32 v117, v154, v155
v_exp_f32 v157, v157
v_exp_f32 v158, v158
v_cvt_pk_bf16_f32 v118, v156, v157
v_exp_f32 v159, v159
v_exp_f32 v128, v128
v_cvt_pk_bf16_f32 v119, v158, v159
v_exp_f32 v129, v129
v_exp_f32 v130, v130
v_mfma_f32_32x32x16_bf16 a[48:63], v[60:63], v[116:119], a[48:63]
s_waitcnt vmcnt(32)
v_cvt_pk_bf16_f32 v112, v128, v129
v_exp_f32 v131, v131
v_exp_f32 v132, v132
v_cvt_pk_bf16_f32 v113, v130, v131
v_mfma_f32_32x32x16_bf16 v[144:159], v[64:67], v[24:27], 0
buffer_load_dwordx4 v[48:51], v0, s[16:19], s61 offen offset:0 sc1
v_exp_f32 v133, v133
v_exp_f32 v134, v134
v_cvt_pk_bf16_f32 v114, v132, v133
v_exp_f32 v135, v135
v_mfma_f32_32x32x16_bf16 v[144:159], v[68:71], v[28:31], v[144:159]
buffer_load_dwordx4 v0, s[16:19], s67 offen offset:3072 sc1 lds
v_exp_f32 v136, v136
v_cvt_pk_bf16_f32 v115, v134, v135
v_exp_f32 v137, v137
v_exp_f32 v138, v138
v_cvt_pk_bf16_f32 v116, v136, v137
v_mfma_f32_32x32x16_bf16 a[0:15], v[72:75], v[112:115], a[0:15]
s_add_u32 s67, s67, 4096
v_exp_f32 v139, v139
v_exp_f32 v140, v140
v_cvt_pk_bf16_f32 v117, v138, v139
v_exp_f32 v141, v141
v_exp_f32 v142, v142
v_cvt_pk_bf16_f32 v118, v140, v141
v_exp_f32 v143, v143
v_exp_f32 v144, v144
v_cvt_pk_bf16_f32 v119, v142, v143
v_exp_f32 v145, v145
v_exp_f32 v146, v146
v_mfma_f32_32x32x16_bf16 a[0:15], v[76:79], v[116:119], a[0:15]
v_cvt_pk_bf16_f32 v112, v144, v145
v_exp_f32 v147, v147
v_exp_f32 v148, v148
v_cvt_pk_bf16_f32 v113, v146, v147
v_mfma_f32_32x32x16_bf16 v[128:143], v[64:67], v[32:35], 0
buffer_load_dwordx4 v[52:55], v0, s[16:19], s61 offen offset:1024 sc1
s_add_u32 m0, s68, 4096
v_exp_f32 v149, v149
v_exp_f32 v150, v150
v_cvt_pk_bf16_f32 v114, v148, v149
v_exp_f32 v151, v151
v_mfma_f32_32x32x16_bf16 v[128:143], v[68:71], v[36:39], v[128:143]
buffer_load_dwordx4 v0, s[16:19], s67 offen offset:0 sc1 lds
v_exp_f32 v152, v152
v_cvt_pk_bf16_f32 v115, v150, v151
v_exp_f32 v153, v153
v_exp_f32 v154, v154
v_cvt_pk_bf16_f32 v116, v152, v153
v_mfma_f32_32x32x16_bf16 a[16:31], v[72:75], v[112:115], a[16:31]
v_exp_f32 v155, v155
v_exp_f32 v156, v156
v_cvt_pk_bf16_f32 v117, v154, v155
v_exp_f32 v157, v157
v_exp_f32 v158, v158
v_cvt_pk_bf16_f32 v118, v156, v157
v_exp_f32 v159, v159
v_exp_f32 v128, v128
v_cvt_pk_bf16_f32 v119, v158, v159
v_exp_f32 v129, v129
v_exp_f32 v130, v130
v_mfma_f32_32x32x16_bf16 a[16:31], v[76:79], v[116:119], a[16:31]
s_waitcnt vmcnt(11)
buffer_store_dword v13, v15, s[16:19], s55 offen sc1
v_cvt_pk_bf16_f32 v112, v128, v129
v_exp_f32 v131, v131
v_exp_f32 v132, v132
v_cvt_pk_bf16_f32 v113, v130, v131
v_mfma_f32_32x32x16_bf16 v[144:159], v[64:67], v[40:43], 0
buffer_load_dwordx4 v[56:59], v0, s[16:19], s61 offen offset:2048 sc1
v_exp_f32 v133, v133
v_exp_f32 v134, v134
v_cvt_pk_bf16_f32 v114, v132, v133
v_exp_f32 v135, v135
v_mfma_f32_32x32x16_bf16 v[144:159], v[68:71], v[44:47], v[144:159]
buffer_load_dwordx4 v0, s[16:19], s67 offen offset:1024 sc1 lds
v_exp_f32 v136, v136
v_cvt_pk_bf16_f32 v115, v134, v135
v_exp_f32 v137, v137
v_exp_f32 v138, v138
v_cvt_pk_bf16_f32 v116, v136, v137
v_mfma_f32_32x32x16_bf16 a[32:47], v[72:75], v[112:115], a[32:47]
v_exp_f32 v139, v139
v_exp_f32 v140, v140
v_cvt_pk_bf16_f32 v117, v138, v139
v_exp_f32 v141, v141
v_exp_f32 v142, v142
v_cvt_pk_bf16_f32 v118, v140, v141
v_exp_f32 v143, v143
v_exp_f32 v144, v144
v_cvt_pk_bf16_f32 v119, v142, v143
v_exp_f32 v145, v145
v_exp_f32 v146, v146
v_mfma_f32_32x32x16_bf16 a[32:47], v[76:79], v[116:119], a[32:47]
v_cvt_pk_bf16_f32 v112, v144, v145
v_exp_f32 v147, v147
v_exp_f32 v148, v148
v_cvt_pk_bf16_f32 v113, v146, v147
v_mfma_f32_32x32x16_bf16 v[128:143], v[80:83], v[16:19], 0
buffer_load_dwordx4 v[60:63], v0, s[16:19], s61 offen offset:3072 sc1
s_add_u32 s61, s61, 4096
v_exp_f32 v149, v149
v_exp_f32 v150, v150
v_cvt_pk_bf16_f32 v114, v148, v149
v_exp_f32 v151, v151
v_mfma_f32_32x32x16_bf16 v[128:143], v[84:87], v[20:23], v[128:143]
buffer_load_dwordx4 v0, s[16:19], s67 offen offset:2048 sc1 lds
v_exp_f32 v152, v152
v_cvt_pk_bf16_f32 v115, v150, v151
v_exp_f32 v153, v153
v_exp_f32 v154, v154
v_cvt_pk_bf16_f32 v116, v152, v153
v_mfma_f32_32x32x16_bf16 a[48:63], v[72:75], v[112:115], a[48:63]
v_exp_f32 v155, v155
v_exp_f32 v156, v156
v_cvt_pk_bf16_f32 v117, v154, v155
v_exp_f32 v157, v157
v_exp_f32 v158, v158
v_cvt_pk_bf16_f32 v118, v156, v157
v_exp_f32 v159, v159
v_exp_f32 v128, v128
v_cvt_pk_bf16_f32 v119, v158, v159
v_exp_f32 v129, v129
v_exp_f32 v130, v130
v_mfma_f32_32x32x16_bf16 a[48:63], v[76:79], v[116:119], a[48:63]
v_cvt_pk_bf16_f32 v112, v128, v129
v_exp_f32 v131, v131
v_exp_f32 v132, v132
v_cvt_pk_bf16_f32 v113, v130, v131
v_mfma_f32_32x32x16_bf16 v[144:159], v[80:83], v[24:27], 0
buffer_load_dwordx4 v[64:67], v0, s[16:19], s61 offen offset:0 sc1
v_exp_f32 v133, v133
v_exp_f32 v134, v134
v_cvt_pk_bf16_f32 v114, v132, v133
v_exp_f32 v135, v135
v_mfma_f32_32x32x16_bf16 v[144:159], v[84:87], v[28:31], v[144:159]
buffer_load_dwordx4 v0, s[16:19], s67 offen offset:3072 sc1 lds
v_exp_f32 v136, v136
v_cvt_pk_bf16_f32 v115, v134, v135
v_exp_f32 v137, v137
v_exp_f32 v138, v138
v_cvt_pk_bf16_f32 v116, v136, v137
v_mfma_f32_32x32x16_bf16 a[0:15], v[88:91], v[112:115], a[0:15]
s_add_u32 s67, s67, 4096
v_exp_f32 v139, v139
v_exp_f32 v140, v140
v_cvt_pk_bf16_f32 v117, v138, v139
v_exp_f32 v141, v141
v_exp_f32 v142, v142
v_cvt_pk_bf16_f32 v118, v140, v141
v_exp_f32 v143, v143
v_exp_f32 v144, v144
v_cvt_pk_bf16_f32 v119, v142, v143
v_exp_f32 v145, v145
v_exp_f32 v146, v146
v_mfma_f32_32x32x16_bf16 a[0:15], v[92:95], v[116:119], a[0:15]
buffer_load_dword v9, v8, s[24:27], s63 offen sc1
v_cvt_pk_bf16_f32 v112, v144, v145
v_exp_f32 v147, v147
v_exp_f32 v148, v148
v_cvt_pk_bf16_f32 v113, v146, v147
v_mfma_f32_32x32x16_bf16 v[128:143], v[80:83], v[32:35], 0
buffer_load_dwordx4 v[68:71], v0, s[16:19], s61 offen offset:1024 sc1
s_add_u32 m0, s68, 8192
v_exp_f32 v149, v149
v_exp_f32 v150, v150
v_cvt_pk_bf16_f32 v114, v148, v149
v_exp_f32 v151, v151
v_mfma_f32_32x32x16_bf16 v[128:143], v[84:87], v[36:39], v[128:143]
buffer_load_dwordx4 v0, s[16:19], s67 offen offset:0 sc1 lds
v_exp_f32 v152, v152
v_cvt_pk_bf16_f32 v115, v150, v151
v_exp_f32 v153, v153
v_exp_f32 v154, v154
v_cvt_pk_bf16_f32 v116, v152, v153
v_mfma_f32_32x32x16_bf16 a[16:31], v[88:91], v[112:115], a[16:31]
v_exp_f32 v155, v155
v_exp_f32 v156, v156
v_cvt_pk_bf16_f32 v117, v154, v155
v_exp_f32 v157, v157
v_exp_f32 v158, v158
v_cvt_pk_bf16_f32 v118, v156, v157
v_exp_f32 v159, v159
v_exp_f32 v128, v128
v_cvt_pk_bf16_f32 v119, v158, v159
v_exp_f32 v129, v129
v_exp_f32 v130, v130
v_mfma_f32_32x32x16_bf16 a[16:31], v[92:95], v[116:119], a[16:31]
v_cvt_pk_bf16_f32 v112, v128, v129
v_exp_f32 v131, v131
v_exp_f32 v132, v132
v_cvt_pk_bf16_f32 v113, v130, v131
v_mfma_f32_32x32x16_bf16 v[144:159], v[80:83], v[40:43], 0
buffer_load_dwordx4 v[72:75], v0, s[16:19], s61 offen offset:2048 sc1
v_exp_f32 v133, v133
v_exp_f32 v134, v134
v_cvt_pk_bf16_f32 v114, v132, v133
v_exp_f32 v135, v135
v_mfma_f32_32x32x16_bf16 v[144:159], v[84:87], v[44:47], v[144:159]
buffer_load_dwordx4 v0, s[16:19], s67 offen offset:1024 sc1 lds
v_exp_f32 v136, v136
v_cvt_pk_bf16_f32 v115, v134, v135
v_exp_f32 v137, v137
v_exp_f32 v138, v138
v_cvt_pk_bf16_f32 v116, v136, v137
v_mfma_f32_32x32x16_bf16 a[32:47], v[88:91], v[112:115], a[32:47]
v_exp_f32 v139, v139
v_exp_f32 v140, v140
v_cvt_pk_bf16_f32 v117, v138, v139
v_exp_f32 v141, v141
v_exp_f32 v142, v142
v_cvt_pk_bf16_f32 v118, v140, v141
v_exp_f32 v143, v143
v_exp_f32 v144, v144
v_cvt_pk_bf16_f32 v119, v142, v143
v_exp_f32 v145, v145
v_exp_f32 v146, v146
v_mfma_f32_32x32x16_bf16 a[32:47], v[92:95], v[116:119], a[32:47]
s_waitcnt vmcnt(21)
v_cvt_pk_bf16_f32 v112, v144, v145
v_exp_f32 v147, v147
v_exp_f32 v148, v148
v_cvt_pk_bf16_f32 v113, v146, v147
v_mfma_f32_32x32x16_bf16 v[128:143], v[96:99], v[16:19], 0
buffer_load_dwordx4 v[76:79], v0, s[16:19], s61 offen offset:3072 sc1
s_add_u32 s61, s61, 4096
v_exp_f32 v149, v149
v_exp_f32 v150, v150
v_cvt_pk_bf16_f32 v114, v148, v149
v_exp_f32 v151, v151
v_mfma_f32_32x32x16_bf16 v[128:143], v[100:103], v[20:23], v[128:143]
buffer_load_dwordx4 v0, s[16:19], s67 offen offset:2048 sc1 lds
v_exp_f32 v152, v152
v_cvt_pk_bf16_f32 v115, v150, v151
v_exp_f32 v153, v153
v_exp_f32 v154, v154
v_cvt_pk_bf16_f32 v116, v152, v153
v_mfma_f32_32x32x16_bf16 a[48:63], v[88:91], v[112:115], a[48:63]
v_exp_f32 v155, v155
v_exp_f32 v156, v156
v_cvt_pk_bf16_f32 v117, v154, v155
v_exp_f32 v157, v157
v_exp_f32 v158, v158
v_cvt_pk_bf16_f32 v118, v156, v157
v_exp_f32 v159, v159
v_exp_f32 v128, v128
v_cvt_pk_bf16_f32 v119, v158, v159
v_exp_f32 v129, v129
v_exp_f32 v130, v130
v_mfma_f32_32x32x16_bf16 a[48:63], v[92:95], v[116:119], a[48:63]
s_waitcnt vmcnt(19)
s_waitcnt vmcnt(6)
v_cmp_ne_u32 vcc, s60, v9
s_cbranch_vccnz F_H_RT
F_H_GO:
v_cvt_pk_bf16_f32 v112, v128, v129
v_exp_f32 v131, v131
v_exp_f32 v132, v132
v_cvt_pk_bf16_f32 v113, v130, v131
v_mfma_f32_32x32x16_bf16 v[144:159], v[96:99], v[24:27], 0
buffer_load_dwordx4 v[80:83], v0, s[16:19], s61 offen offset:0 sc1
buffer_load_dwordx4 a[136:139], v242, s[24:27], s66 offen offset:0 sc1
v_exp_f32 v133, v133
v_exp_f32 v134, v134
v_cvt_pk_bf16_f32 v114, v132, v133
v_exp_f32 v135, v135
v_mfma_f32_32x32x16_bf16 v[144:159], v[100:103], v[28:31], v[144:159]
buffer_load_dwordx4 a[140:143], v243, s[24:27], s66 offen offset:0 sc1
buffer_load_dwordx4 v0, s[16:19], s67 offen offset:3072 sc1 lds
v_exp_f32 v136, v136
v_cvt_pk_bf16_f32 v115, v134, v135
v_exp_f32 v137, v137
v_exp_f32 v138, v138
v_cvt_pk_bf16_f32 v116, v136, v137
v_mfma_f32_32x32x16_bf16 a[0:15], v[104:107], v[112:115], a[0:15]
buffer_load_dwordx4 a[152:155], v242, s[24:27], s66 offen offset:2048 sc1
s_add_u32 s67, s67, 4096
v_exp_f32 v139, v139
v_exp_f32 v140, v140
v_cvt_pk_bf16_f32 v117, v138, v139
v_exp_f32 v141, v141
v_exp_f32 v142, v142
v_cvt_pk_bf16_f32 v118, v140, v141
v_exp_f32 v143, v143
v_exp_f32 v144, v144
v_cvt_pk_bf16_f32 v119, v142, v143
v_exp_f32 v145, v145
v_exp_f32 v146, v146
v_mfma_f32_32x32x16_bf16 a[0:15], v[108:111], v[116:119], a[0:15]
buffer_load_dwordx4 a[156:159], v243, s[24:27], s66 offen offset:2048 sc1
s_add_u32 s66, s66, 4096
v_cvt_pk_bf16_f32 v112, v144, v145
v_exp_f32 v147, v147
v_exp_f32 v148, v148
v_cvt_pk_bf16_f32 v113, v146, v147
v_mfma_f32_32x32x16_bf16 v[128:143], v[96:99], v[32:35], 0
buffer_load_dwordx4 v[84:87], v0, s[16:19], s61 offen offset:1024 sc1
buffer_load_dwordx4 a[168:171], v242, s[24:27], s66 offen offset:0 sc1
s_add_u32 m0, s68, 12288
v_exp_f32 v149, v149
v_exp_f32 v150, v150
v_cvt_pk_bf16_f32 v114, v148, v149
v_exp_f32 v151, v151
v_mfma_f32_32x32x16_bf16 v[128:143], v[100:103], v[36:39], v[128:143]
buffer_load_dwordx4 a[172:175], v243, s[24:27], s66 offen offset:0 sc1
buffer_load_dwordx4 v0, s[16:19], s67 offen offset:0 sc1 lds
v_exp_f32 v152, v152
v_cvt_pk_bf16_f32 v115, v150, v151
v_exp_f32 v153, v153
v_exp_f32 v154, v154
v_cvt_pk_bf16_f32 v116, v152, v153
v_mfma_f32_32x32x16_bf16 a[16:31], v[104:107], v[112:115], a[16:31]
buffer_load_dwordx4 a[184:187], v242, s[24:27], s66 offen offset:2048 sc1
v_exp_f32 v155, v155
v_exp_f32 v156, v156
v_cvt_pk_bf16_f32 v117, v154, v155
v_exp_f32 v157, v157
v_exp_f32 v158, v158
v_cvt_pk_bf16_f32 v118, v156, v157
v_exp_f32 v159, v159
v_exp_f32 v128, v128
v_cvt_pk_bf16_f32 v119, v158, v159
v_exp_f32 v129, v129
v_exp_f32 v130, v130
v_mfma_f32_32x32x16_bf16 a[16:31], v[108:111], v[116:119], a[16:31]
buffer_load_dwordx4 a[188:191], v243, s[24:27], s66 offen offset:2048 sc1
s_add_u32 s66, s66, 4096
v_cvt_pk_bf16_f32 v112, v128, v129
v_exp_f32 v131, v131
v_exp_f32 v132, v132
v_cvt_pk_bf16_f32 v113, v130, v131
v_mfma_f32_32x32x16_bf16 v[144:159], v[96:99], v[40:43], 0
buffer_load_dwordx4 v[88:91], v0, s[16:19], s61 offen offset:2048 sc1
buffer_load_dwordx4 a[200:203], v242, s[24:27], s66 offen offset:0 sc1
v_exp_f32 v133, v133
v_exp_f32 v134, v134
v_cvt_pk_bf16_f32 v114, v132, v133
v_exp_f32 v135, v135
v_mfma_f32_32x32x16_bf16 v[144:159], v[100:103], v[44:47], v[144:159]
buffer_load_dwordx4 a[204:207], v243, s[24:27], s66 offen offset:0 sc1
buffer_load_dwordx4 v0, s[16:19], s67 offen offset:1024 sc1 lds
v_exp_f32 v136, v136
v_cvt_pk_bf16_f32 v115, v134, v135
v_exp_f32 v137, v137
v_exp_f32 v138, v138
v_cvt_pk_bf16_f32 v116, v136, v137
v_mfma_f32_32x32x16_bf16 a[32:47], v[104:107], v[112:115], a[32:47]
buffer_load_dwordx4 a[216:219], v242, s[24:27], s66 offen offset:2048 sc1
v_exp_f32 v139, v139
v_exp_f32 v140, v140
v_cvt_pk_bf16_f32 v117, v138, v139
v_exp_f32 v141, v141
v_exp_f32 v142, v142
v_cvt_pk_bf16_f32 v118, v140, v141
v_exp_f32 v143, v143
v_exp_f32 v144, v144
v_cvt_pk_bf16_f32 v119, v142, v143
v_exp_f32 v145, v145
v_exp_f32 v146, v146
v_mfma_f32_32x32x16_bf16 a[32:47], v[108:111], v[116:119], a[32:47]
buffer_load_dwordx4 a[220:223], v243, s[24:27], s66 offen offset:2048 sc1
s_add_u32 s66, s66, 4096
v_cvt_pk_bf16_f32 v112, v144, v145
v_exp_f32 v147, v147
v_exp_f32 v148, v148
v_cvt_pk_bf16_f32 v113, v146, v147
v_mfma_f32_32x32x16_bf16 v[128:143], v[48:51], v[16:19], 0
buffer_load_dwordx4 v[92:95], v0, s[16:19], s61 offen offset:3072 sc1
s_add_u32 s61, s61, 4096
buffer_load_dwordx4 a[232:235], v242, s[24:27], s66 offen offset:0 sc1
v_exp_f32 v149, v149
v_exp_f32 v150, v150
v_cvt_pk_bf16_f32 v114, v148, v149
v_exp_f32 v151, v151
v_mfma_f32_32x32x16_bf16 v[128:143], v[52:55], v[20:23], v[128:143]
buffer_load_dwordx4 a[236:239], v243, s[24:27], s66 offen offset:0 sc1
buffer_load_dwordx4 v0, s[16:19], s67 offen offset:2048 sc1 lds
v_exp_f32 v152, v152
v_cvt_pk_bf16_f32 v115, v150, v151
v_exp_f32 v153, v153
v_exp_f32 v154, v154
v_cvt_pk_bf16_f32 v116, v152, v153
v_mfma_f32_32x32x16_bf16 a[48:63], v[104:107], v[112:115], a[48:63]
buffer_load_dwordx4 a[248:251], v242, s[24:27], s66 offen offset:2048 sc1
v_exp_f32 v155, v155
v_exp_f32 v156, v156
v_cvt_pk_bf16_f32 v117, v154, v155
v_exp_f32 v157, v157
v_exp_f32 v158, v158
v_cvt_pk_bf16_f32 v118, v156, v157
v_exp_f32 v159, v159
v_exp_f32 v128, v128
v_cvt_pk_bf16_f32 v119, v158, v159
v_exp_f32 v129, v129
v_exp_f32 v130, v130
v_mfma_f32_32x32x16_bf16 a[48:63], v[108:111], v[116:119], a[48:63]
buffer_load_dwordx4 a[252:255], v243, s[24:27], s66 offen offset:2048 sc1
s_add_u32 s66, s66, 4096
v_cvt_pk_bf16_f32 v112, v128, v129
v_exp_f32 v131, v131
v_exp_f32 v132, v132
v_cvt_pk_bf16_f32 v113, v130, v131
v_mfma_f32_32x32x16_bf16 v[144:159], v[48:51], v[24:27], 0
buffer_load_dwordx4 v[96:99], v0, s[16:19], s61 offen offset:0 sc1
v_exp_f32 v133, v133
v_exp_f32 v134, v134
v_cvt_pk_bf16_f32 v114, v132, v133
v_exp_f32 v135, v135
v_mfma_f32_32x32x16_bf16 v[144:159], v[52:55], v[28:31], v[144:159]
buffer_load_dwordx4 v0, s[16:19], s67 offen offset:3072 sc1 lds
v_exp_f32 v136, v136
v_cvt_pk_bf16_f32 v115, v134, v135
v_exp_f32 v137, v137
v_exp_f32 v138, v138
v_cvt_pk_bf16_f32 v116, v136, v137
v_mfma_f32_32x32x16_bf16 a[0:15], v[56:59], v[112:115], a[0:15]
s_add_u32 s67, s67, 4096
v_exp_f32 v139, v139
v_exp_f32 v140, v140
v_cvt_pk_bf16_f32 v117, v138, v139
v_exp_f32 v141, v141
v_exp_f32 v142, v142
v_cvt_pk_bf16_f32 v118, v140, v141
v_exp_f32 v143, v143
v_exp_f32 v144, v144
v_cvt_pk_bf16_f32 v119, v142, v143
v_exp_f32 v145, v145
v_exp_f32 v146, v146
v_mfma_f32_32x32x16_bf16 a[0:15], v[60:63], v[116:119], a[0:15]
s_waitcnt vmcnt(23)
v_cvt_pk_bf16_f32 v112, v144, v145
v_exp_f32 v147, v147
v_exp_f32 v148, v148
v_mfma_f32_32x32x16_bf16 v[128:143], v[48:51], v[32:35], 0
buffer_load_dwordx4 v[100:103], v0, s[16:19], s61 offen offset:1024 sc1
v_cvt_pk_bf16_f32 v113, v146, v147
v_exp_f32 v149, v149
v_exp_f32 v150, v150
v_mfma_f32_32x32x16_bf16 v[128:143], v[52:55], v[36:39], v[128:143]
v_cvt_pk_bf16_f32 v114, v148, v149
v_exp_f32 v151, v151
v_exp_f32 v152, v152
v_mfma_f32_32x32x16_bf16 a[64:79], a[128:131], a[136:139], 0
v_cvt_pk_bf16_f32 v115, v150, v151
v_exp_f32 v153, v153
v_exp_f32 v154, v154
v_mfma_f32_32x32x16_bf16 a[16:31], v[56:59], v[112:115], a[16:31]
v_cvt_pk_bf16_f32 v116, v152, v153
v_exp_f32 v155, v155
v_exp_f32 v156, v156
v_cvt_pk_bf16_f32 v117, v154, v155
v_mfma_f32_32x32x16_bf16 a[80:95], a[132:135], a[136:139], 0
v_exp_f32 v157, v157
v_exp_f32 v158, v158
v_cvt_pk_bf16_f32 v118, v156, v157
v_exp_f32 v159, v159
v_mfma_f32_32x32x16_bf16 a[96:111], a[128:131], a[140:143], 0
v_exp_f32 v128, v128
v_cvt_pk_bf16_f32 v119, v158, v159
v_exp_f32 v129, v129
v_exp_f32 v130, v130
v_mfma_f32_32x32x16_bf16 a[16:31], v[60:63], v[116:119], a[16:31]
s_waitcnt vmcnt(21)
v_cvt_pk_bf16_f32 v112, v128, v129
v_exp_f32 v131, v131
v_exp_f32 v132, v132
v_cvt_pk_bf16_f32 v113, v130, v131
v_mfma_f32_32x32x16_bf16 v[144:159], v[48:51], v[40:43], 0
buffer_load_dwordx4 v[104:107], v0, s[16:19], s61 offen offset:2048 sc1
v_exp_f32 v133, v133
v_exp_f32 v134, v134
v_cvt_pk_bf16_f32 v114, v132, v133
v_exp_f32 v135, v135
v_mfma_f32_32x32x16_bf16 v[144:159], v[52:55], v[44:47], v[144:159]
v_exp_f32 v136, v136
v_cvt_pk_bf16_f32 v115, v134, v135
v_exp_f32 v137, v137
v_exp_f32 v138, v138
v_mfma_f32_32x32x16_bf16 a[32:47], v[56:59], v[112:115], a[32:47]
v_cvt_pk_bf16_f32 v116, v136, v137
v_exp_f32 v139, v139
v_exp_f32 v140, v140
v_cvt_pk_bf16_f32 v117, v138, v139
v_mfma_f32_32x32x16_bf16 a[112:127], a[132:135], a[140:143], 0
v_exp_f32 v141, v141
v_exp_f32 v142, v142
v_cvt_pk_bf16_f32 v118, v140, v141
v_exp_f32 v143, v143
v_mfma_f32_32x32x16_bf16 a[64:79], a[144:147], a[152:155], a[64:79]
buffer_load_dwordx4 a[128:131], v240, s[24:27], s65 offen offset:0 sc1
v_exp_f32 v144, v144
v_cvt_pk_bf16_f32 v119, v142, v143
v_exp_f32 v145, v145
v_exp_f32 v146, v146
v_mfma_f32_32x32x16_bf16 a[32:47], v[60:63], v[116:119], a[32:47]
v_cvt_pk_bf16_f32 v112, v144, v145
v_exp_f32 v147, v147
v_exp_f32 v148, v148
v_mfma_f32_32x32x16_bf16 v[128:143], v[64:67], v[16:19], 0
buffer_load_dwordx4 v[108:111], v0, s[16:19], s61 offen offset:3072 sc1
s_add_u32 s61, s61, 4096
v_cvt_pk_bf16_f32 v113, v146, v147
v_exp_f32 v149, v149
v_exp_f32 v150, v150
v_mfma_f32_32x32x16_bf16 v[128:143], v[68:71], v[20:23], v[128:143]
v_cvt_pk_bf16_f32 v114, v148, v149
v_exp_f32 v151, v151
v_exp_f32 v152, v152
v_mfma_f32_32x32x16_bf16 a[80:95], a[148:151], a[152:155], a[80:95]
buffer_load_dwordx4 a[136:139], v242, s[24:27], s66 offen offset:0 sc1
v_cvt_pk_bf16_f32 v115, v150, v151
v_exp_f32 v153, v153
v_exp_f32 v154, v154
v_mfma_f32_32x32x16_bf16 a[48:63], v[56:59], v[112:115], a[48:63]
v_cvt_pk_bf16_f32 v116, v152, v153
v_exp_f32 v155, v155
v_exp_f32 v156, v156
v_cvt_pk_bf16_f32 v117, v154, v155
v_mfma_f32_32x32x16_bf16 a[96:111], a[144:147], a[156:159], a[96:111]
buffer_load_dwordx4 a[132:135], v241, s[24:27], s65 offen offset:0 sc1
v_exp_f32 v157, v157
v_exp_f32 v158, v158
v_cvt_pk_bf16_f32 v118, v156, v157
v_exp_f32 v159, v159
v_mfma_f32_32x32x16_bf16 a[112:127], a[148:151], a[156:159], a[112:127]
buffer_load_dwordx4 a[140:143], v243, s[24:27], s66 offen offset:0 sc1
v_exp_f32 v128, v128
v_cvt_pk_bf16_f32 v119, v158, v159
v_exp_f32 v129, v129
v_exp_f32 v130, v130
v_mfma_f32_32x32x16_bf16 a[48:63], v[60:63], v[116:119], a[48:63]
s_waitcnt vmcnt(24)
v_cvt_pk_bf16_f32 v112, v128, v129
v_exp_f32 v131, v131
v_exp_f32 v132, v132
v_cvt_pk_bf16_f32 v113, v130, v131
v_mfma_f32_32x32x16_bf16 v[144:159], v[64:67], v[24:27], 0
buffer_load_dwordx4 v[48:51], v0, s[16:19], s61 offen offset:0 sc1
v_exp_f32 v133, v133
v_exp_f32 v134, v134
v_cvt_pk_bf16_f32 v114, v132, v133
v_exp_f32 v135, v135
v_mfma_f32_32x32x16_bf16 v[144:159], v[68:71], v[28:31], v[144:159]
v_exp_f32 v136, v136
v_cvt_pk_bf16_f32 v115, v134, v135
v_exp_f32 v137, v137
v_exp_f32 v138, v138
v_mfma_f32_32x32x16_bf16 a[0:15], v[72:75], v[112:115], a[0:15]
v_cvt_pk_bf16_f32 v116, v136, v137
v_exp_f32 v139, v139
v_exp_f32 v140, v140
v_cvt_pk_bf16_f32 v117, v138, v139
v_mfma_f32_32x32x16_bf16 a[64:79], a[160:163], a[168:171], a[64:79]
buffer_load_dwordx4 a[144:147], v240, s[24:27], s65 offen offset:2048 sc1
v_exp_f32 v141, v141
v_exp_f32 v142, v142
v_cvt_pk_bf16_f32 v118, v140, v141
v_exp_f32 v143, v143
v_mfma_f32_32x32x16_bf16 a[80:95], a[164:167], a[168:171], a[80:95]
buffer_load_dwordx4 a[152:155], v242, s[24:27], s66 offen offset:2048 sc1
v_exp_f32 v144, v144
v_cvt_pk_bf16_f32 v119, v142, v143
v_exp_f32 v145, v145
v_exp_f32 v146, v146
v_mfma_f32_32x32x16_bf16 a[0:15], v[76:79], v[116:119], a[0:15]
v_cvt_pk_bf16_f32 v112, v144, v145
v_exp_f32 v147, v147
v_exp_f32 v148, v148
v_cvt_pk_bf16_f32 v113, v146, v147
v_mfma_f32_32x32x16_bf16 v[128:143], v[64:67], v[32:35], 0
buffer_load_dwordx4 v[52:55], v0, s[16:19], s61 offen offset:1024 sc1
v_exp_f32 v149, v149
v_exp_f32 v150, v150
v_cvt_pk_bf16_f32 v114, v148, v149
v_exp_f32 v151, v151
v_mfma_f32_32x32x16_bf16 v[128:143], v[68:71], v[36:39], v[128:143]
v_exp_f32 v152, v152
v_cvt_pk_bf16_f32 v115, v150, v151
v_exp_f32 v153, v153
v_exp_f32 v154, v154
v_mfma_f32_32x32x16_bf16 a[16:31], v[72:75], v[112:115], a[16:31]
v_cvt_pk_bf16_f32 v116, v152, v153
v_exp_f32 v155, v155
v_exp_f32 v156, v156
v_cvt_pk_bf16_f32 v117, v154, v155
v_mfma_f32_32x32x16_bf16 a[96:111], a[160:163], a[172:175], a[96:111]
buffer_load_dwordx4 a[148:151], v241, s[24:27], s65 offen offset:2048 sc1
s_add_u32 s65, s65, 4096
v_exp_f32 v157, v157
v_exp_f32 v158, v158
v_cvt_pk_bf16_f32 v118, v156, v157
v_exp_f32 v159, v159
v_mfma_f32_32x32x16_bf16 a[112:127], a[164:167], a[172:175], a[112:127]
buffer_load_dwordx4 a[156:159], v243, s[24:27], s66 offen offset:2048 sc1
s_add_u32 s66, s66, 4096
v_exp_f32 v128, v128
v_cvt_pk_bf16_f32 v119, v158, v159
v_exp_f32 v129, v129
v_exp_f32 v130, v130
v_mfma_f32_32x32x16_bf16 a[16:31], v[76:79], v[116:119], a[16:31]
s_waitcnt vmcnt(27)
v_cvt_pk_bf16_f32 v112, v128, v129
v_exp_f32 v131, v131
v_exp_f32 v132, v132
v_mfma_f32_32x32x16_bf16 v[144:159], v[64:67], v[40:43], 0
buffer_load_dwordx4 v[56:59], v0, s[16:19], s61 offen offset:2048 sc1
v_cvt_pk_bf16_f32 v113, v130, v131
v_exp_f32 v133, v133
v_exp_f32 v134, v134
v_mfma_f32_32x32x16_bf16 v[144:159], v[68:71], v[44:47], v[144:159]
v_cvt_pk_bf16_f32 v114, v132, v133
v_exp_f32 v135, v135
v_exp_f32 v136, v136
v_mfma_f32_32x32x16_bf16 a[64:79], a[176:179], a[184:187], a[64:79]
buffer_load_dwordx4 a[160:163], v240, s[24:27], s65 offen offset:0 sc1
v_cvt_pk_bf16_f32 v115, v134, v135
v_exp_f32 v137, v137
v_exp_f32 v138, v138
v_mfma_f32_32x32x16_bf16 a[32:47], v[72:75], v[112:115], a[32:47]
v_cvt_pk_bf16_f32 v116, v136, v137
v_exp_f32 v139, v139
v_exp_f32 v140, v140
v_cvt_pk_bf16_f32 v117, v138, v139
v_mfma_f32_32x32x16_bf16 a[80:95], a[180:183], a[184:187], a[80:95]
buffer_load_dwordx4 a[168:171], v242, s[24:27], s66 offen offset:0 sc1
v_exp_f32 v141, v141
v_exp_f32 v142, v142
v_cvt_pk_bf16_f32 v118, v140, v141
v_exp_f32 v143, v143
v_mfma_f32_32x32x16_bf16 a[96:111], a[176:179], a[188:191], a[96:111]
buffer_load_dwordx4 a[164:167], v241, s[24:27], s65 offen offset:0 sc1
v_exp_f32 v144, v144
v_cvt_pk_bf16_f32 v119, v142, v143
v_exp_f32 v145, v145
v_exp_f32 v146, v146
v_mfma_f32_32x32x16_bf16 a[32:47], v[76:79], v[116:119], a[32:47]
s_waitcnt vmcnt(28)
v_cvt_pk_bf16_f32 v112, v144, v145
v_exp_f32 v147, v147
v_exp_f32 v148, v148
v_cvt_pk_bf16_f32 v113, v146, v147
v_mfma_f32_32x32x16_bf16 v[128:143], v[80:83], v[16:19], 0
buffer_load_dwordx4 v[60:63], v0, s[16:19], s61 offen offset:3072 sc1
s_add_u32 s61, s61, 4096
v_exp_f32 v149, v149
v_exp_f32 v150, v150
v_cvt_pk_bf16_f32 v114, v148, v149
v_exp_f32 v151, v151
v_mfma_f32_32x32x16_bf16 v[128:143], v[84:87], v[20:23], v[128:143]
v_exp_f32 v152, v152
v_cvt_pk_bf16_f32 v115, v150, v151
v_exp_f32 v153, v153
v_exp_f32 v154, v154
v_mfma_f32_32x32x16_bf16 a[48:63], v[72:75], v[112:115], a[48:63]
v_cvt_pk_bf16_f32 v116, v152, v153
v_exp_f32 v155, v155
v_exp_f32 v156, v156
v_cvt_pk_bf16_f32 v117, v154, v155
v_mfma_f32_32x32x16_bf16 a[112:127], a[180:183], a[188:191], a[112:127]
buffer_load_dwordx4 a[172:175], v243, s[24:27], s66 offen offset:0 sc1
v_exp_f32 v157, v157
v_exp_f32 v158, v158
v_cvt_pk_bf16_f32 v118, v156, v157
v_exp_f32 v159, v159
v_mfma_f32_32x32x16_bf16 a[64:79], a[192:195], a[200:203], a[64:79]
buffer_load_dwordx4 a[176:179], v240, s[24:27], s65 offen offset:2048 sc1
v_exp_f32 v128, v128
v_cvt_pk_bf16_f32 v119, v158, v159
v_exp_f32 v129, v129
v_exp_f32 v130, v130
v_mfma_f32_32x32x16_bf16 a[48:63], v[76:79], v[116:119], a[48:63]
s_waitcnt vmcnt(27)
v_cvt_pk_bf16_f32 v112, v128, v129
v_exp_f32 v131, v131
v_exp_f32 v132, v132
v_mfma_f32_32x32x16_bf16 v[144:159], v[80:83], v[24:27], 0
buffer_load_dwordx4 v[64:67], v0, s[16:19], s61 offen offset:0 sc1
v_cvt_pk_bf16_f32 v113, v130, v131
v_exp_f32 v133, v133
v_exp_f32 v134, v134
v_mfma_f32_32x32x16_bf16 v[144:159], v[84:87], v[28:31], v[144:159]
v_cvt_pk_bf16_f32 v114, v132, v133
v_exp_f32 v135, v135
v_exp_f32 v136, v136
v_mfma_f32_32x32x16_bf16 a[80:95], a[196:199], a[200:203], a[80:95]
buffer_load_dwordx4 a[184:187], v242, s[24:27], s66 offen offset:2048 sc1
v_cvt_pk_bf16_f32 v115, v134, v135
v_exp_f32 v137, v137
v_exp_f32 v138, v138
v_mfma_f32_32x32x16_bf16 a[0:15], v[88:91], v[112:115], a[0:15]
v_cvt_pk_bf16_f32 v116, v136, v137
v_exp_f32 v139, v139
v_exp_f32 v140, v140
v_cvt_pk_bf16_f32 v117, v138, v139
v_mfma_f32_32x32x16_bf16 a[96:111], a[192:195], a[204:207], a[96:111]
buffer_load_dwordx4 a[180:183], v241, s[24:27], s65 offen offset:2048 sc1
s_add_u32 s65, s65, 4096
v_exp_f32 v141, v141
v_exp_f32 v142, v142
v_cvt_pk_bf16_f32 v118, v140, v141
v_exp_f32 v143, v143
v_mfma_f32_32x32x16_bf16 a[112:127], a[196:199], a[204:207], a[112:127]
buffer_load_dwordx4 a[188:191], v243, s[24:27], s66 offen offset:2048 sc1
s_add_u32 s66, s66, 4096
v_exp_f32 v144, v144
v_cvt_pk_bf16_f32 v119, v142, v143
v_exp_f32 v145, v145
v_exp_f32 v146, v146
v_mfma_f32_32x32x16_bf16 a[0:15], v[92:95], v[116:119], a[0:15]
v_cvt_pk_bf16_f32 v112, v144, v145
v_exp_f32 v147, v147
v_exp_f32 v148, v148
v_cvt_pk_bf16_f32 v113, v146, v147
v_mfma_f32_32x32x16_bf16 v[128:143], v[80:83], v[32:35], 0
buffer_load_dwordx4 v[68:71], v0, s[16:19], s61 offen offset:1024 sc1
v_exp_f32 v149, v149
v_exp_f32 v150, v150
v_cvt_pk_bf16_f32 v114, v148, v149
v_exp_f32 v151, v151
v_mfma_f32_32x32x16_bf16 v[128:143], v[84:87], v[36:39], v[128:143]
v_exp_f32 v152, v152
v_cvt_pk_bf16_f32 v115, v150, v151
v_exp_f32 v153, v153
v_exp_f32 v154, v154
v_mfma_f32_32x32x16_bf16 a[16:31], v[88:91], v[112:115], a[16:31]
v_cvt_pk_bf16_f32 v116, v152, v153
v_exp_f32 v155, v155
v_exp_f32 v156, v156
v_cvt_pk_bf16_f32 v117, v154, v155
v_mfma_f32_32x32x16_bf16 a[64:79], a[208:211], a[216:219], a[64:79]
buffer_load_dwordx4 a[192:195], v240, s[24:27], s65 offen offset:0 sc1
v_exp_f32 v157, v157
v_exp_f32 v158, v158
v_cvt_pk_bf16_f32 v118, v156, v157
v_exp_f32 v159, v159
v_mfma_f32_32x32x16_bf16 a[80:95], a[212:215], a[216:219], a[80:95]
buffer_load_dwordx4 a[200:203], v242, s[24:27], s66 offen offset:0 sc1
v_exp_f32 v128, v128
v_cvt_pk_bf16_f32 v119, v158, v159
v_exp_f32 v129, v129
v_exp_f32 v130, v130
v_mfma_f32_32x32x16_bf16 a[16:31], v[92:95], v[116:119], a[16:31]
v_cvt_pk_bf16_f32 v112, v128, v129
v_exp_f32 v131, v131
v_exp_f32 v132, v132
v_cvt_pk_bf16_f32 v113, v130, v131
v_mfma_f32_32x32x16_bf16 v[144:159], v[80:83], v[40:43], 0
buffer_load_dwordx4 v[72:75], v0, s[16:19], s61 offen offset:2048 sc1
v_exp_f32 v133, v133
v_exp_f32 v134, v134
v_cvt_pk_bf16_f32 v114, v132, v133
v_exp_f32 v135, v135
v_mfma_f32_32x32x16_bf16 v[144:159], v[84:87], v[44:47], v[144:159]
v_exp_f32 v136, v136
v_cvt_pk_bf16_f32 v115, v134, v135
v_exp_f32 v137, v137
v_exp_f32 v138, v138
v_mfma_f32_32x32x16_bf16 a[32:47], v[88:91], v[112:115], a[32:47]
v_cvt_pk_bf16_f32 v116, v136, v137
v_exp_f32 v139, v139
v_exp_f32 v140, v140
v_cvt_pk_bf16_f32 v117, v138, v139
v_mfma_f32_32x32x16_bf16 a[96:111], a[208:211], a[220:223], a[96:111]
buffer_load_dwordx4 a[196:199], v241, s[24:27], s65 offen offset:0 sc1
v_exp_f32 v141, v141
v_exp_f32 v142, v142
v_cvt_pk_bf16_f32 v118, v140, v141
v_exp_f32 v143, v143
v_mfma_f32_32x32x16_bf16 a[112:127], a[212:215], a[220:223], a[112:127]
buffer_load_dwordx4 a[204:207], v243, s[24:27], s66 offen offset:0 sc1
v_exp_f32 v144, v144
v_cvt_pk_bf16_f32 v119, v142, v143
v_exp_f32 v145, v145
v_exp_f32 v146, v146
v_mfma_f32_32x32x16_bf16 a[32:47], v[92:95], v[116:119], a[32:47]
s_waitcnt vmcnt(29)
v_cvt_pk_bf16_f32 v112, v144, v145
v_exp_f32 v147, v147
v_exp_f32 v148, v148
v_mfma_f32_32x32x16_bf16 v[128:143], v[96:99], v[16:19], 0
buffer_load_dwordx4 v[76:79], v0, s[16:19], s61 offen offset:3072 sc1
s_add_u32 s61, s61, 4096
v_cvt_pk_bf16_f32 v113, v146, v147
v_exp_f32 v149, v149
v_exp_f32 v150, v150
v_mfma_f32_32x32x16_bf16 v[128:143], v[100:103], v[20:23], v[128:143]
v_cvt_pk_bf16_f32 v114, v148, v149
v_exp_f32 v151, v151
v_exp_f32 v152, v152
v_mfma_f32_32x32x16_bf16 a[64:79], a[224:227], a[232:235], a[64:79]
buffer_load_dwordx4 a[208:211], v240, s[24:27], s65 offen offset:2048 sc1
v_cvt_pk_bf16_f32 v115, v150, v151
v_exp_f32 v153, v153
v_exp_f32 v154, v154
v_mfma_f32_32x32x16_bf16 a[48:63], v[88:91], v[112:115], a[48:63]
v_cvt_pk_bf16_f32 v116, v152, v153
v_exp_f32 v155, v155
v_exp_f32 v156, v156
v_cvt_pk_bf16_f32 v117, v154, v155
v_mfma_f32_32x32x16_bf16 a[80:95], a[228:231], a[232:235], a[80:95]
buffer_load_dwordx4 a[216:219], v242, s[24:27], s66 offen offset:2048 sc1
v_exp_f32 v157, v157
v_exp_f32 v158, v158
v_cvt_pk_bf16_f32 v118, v156, v157
v_exp_f32 v159, v159
v_mfma_f32_32x32x16_bf16 a[96:111], a[224:227], a[236:239], a[96:111]
buffer_load_dwordx4 a[212:215], v241, s[24:27], s65 offen offset:2048 sc1
s_add_u32 s65, s65, 4096
v_exp_f32 v128, v128
v_cvt_pk_bf16_f32 v119, v158, v159
v_exp_f32 v129, v129
v_exp_f32 v130, v130
v_mfma_f32_32x32x16_bf16 a[48:63], v[92:95], v[116:119], a[48:63]
s_waitcnt vmcnt(30)
v_cvt_pk_bf16_f32 v112, v128, v129
v_exp_f32 v131, v131
v_exp_f32 v132, v132
v_cvt_pk_bf16_f32 v113, v130, v131
v_mfma_f32_32x32x16_bf16 v[144:159], v[96:99], v[24:27], 0
buffer_load_dwordx4 v[80:83], v0, s[16:19], s61 offen offset:0 sc1
v_exp_f32 v133, v133
v_exp_f32 v134, v134
v_cvt_pk_bf16_f32 v114, v132, v133
v_exp_f32 v135, v135
v_mfma_f32_32x32x16_bf16 v[144:159], v[100:103], v[28:31], v[144:159]
v_exp_f32 v136, v136
v_cvt_pk_bf16_f32 v115, v134, v135
v_exp_f32 v137, v137
v_exp_f32 v138, v138
v_mfma_f32_32x32x16_bf16 a[0:15], v[104:107], v[112:115], a[0:15]
v_cvt_pk_bf16_f32 v116, v136, v137
v_exp_f32 v139, v139
v_exp_f32 v140, v140
v_cvt_pk_bf16_f32 v117, v138, v139
v_mfma_f32_32x32x16_bf16 a[112:127], a[228:231], a[236:239], a[112:127]
buffer_load_dwordx4 a[220:223], v243, s[24:27], s66 offen offset:2048 sc1
s_add_u32 s66, s66, 4096
v_exp_f32 v141, v141
v_exp_f32 v142, v142
v_cvt_pk_bf16_f32 v118, v140, v141
v_exp_f32 v143, v143
v_mfma_f32_32x32x16_bf16 a[64:79], a[240:243], a[248:251], a[64:79]
buffer_load_dwordx4 a[224:227], v240, s[24:27], s65 offen offset:0 sc1
v_exp_f32 v144, v144
v_cvt_pk_bf16_f32 v119, v142, v143
v_exp_f32 v145, v145
v_exp_f32 v146, v146
v_mfma_f32_32x32x16_bf16 a[0:15], v[108:111], v[116:119], a[0:15]
v_cvt_pk_bf16_f32 v112, v144, v145
v_exp_f32 v147, v147
v_exp_f32 v148, v148
v_cvt_pk_bf16_f32 v113, v146, v147
v_mfma_f32_32x32x16_bf16 v[128:143], v[96:99], v[32:35], 0
buffer_load_dwordx4 v[84:87], v0, s[16:19], s61 offen offset:1024 sc1
v_exp_f32 v149, v149
v_exp_f32 v150, v150
v_cvt_pk_bf16_f32 v114, v148, v149
v_exp_f32 v151, v151
v_mfma_f32_32x32x16_bf16 v[128:143], v[100:103], v[36:39], v[128:143]
v_exp_f32 v152, v152
v_cvt_pk_bf16_f32 v115, v150, v151
v_exp_f32 v153, v153
v_exp_f32 v154, v154
v_mfma_f32_32x32x16_bf16 a[16:31], v[104:107], v[112:115], a[16:31]
v_cvt_pk_bf16_f32 v116, v152, v153
v_exp_f32 v155, v155
v_exp_f32 v156, v156
v_cvt_pk_bf16_f32 v117, v154, v155
v_mfma_f32_32x32x16_bf16 a[80:95], a[244:247], a[248:251], a[80:95]
buffer_load_dwordx4 a[232:235], v242, s[24:27], s66 offen offset:0 sc1
v_exp_f32 v157, v157
v_exp_f32 v158, v158
v_cvt_pk_bf16_f32 v118, v156, v157
v_exp_f32 v159, v159
v_mfma_f32_32x32x16_bf16 a[96:111], a[240:243], a[252:255], a[96:111]
buffer_load_dwordx4 a[228:231], v241, s[24:27], s65 offen offset:0 sc1
v_exp_f32 v128, v128
v_cvt_pk_bf16_f32 v119, v158, v159
v_exp_f32 v129, v129
v_exp_f32 v130, v130
v_mfma_f32_32x32x16_bf16 a[16:31], v[108:111], v[116:119], a[16:31]
s_waitcnt vmcnt(33)
v_cvt_pk_bf16_f32 v112, v128, v129
v_exp_f32 v131, v131
v_exp_f32 v132, v132
v_mfma_f32_32x32x16_bf16 v[144:159], v[96:99], v[40:43], 0
buffer_load_dwordx4 v[88:91], v0, s[16:19], s61 offen offset:2048 sc1
v_cvt_pk_bf16_f32 v113, v130, v131
v_exp_f32 v133, v133
v_exp_f32 v134, v134
v_mfma_f32_32x32x16_bf16 v[144:159], v[100:103], v[44:47], v[144:159]
v_cvt_pk_bf16_f32 v114, v132, v133
v_exp_f32 v135, v135
v_exp_f32 v136, v136
v_mfma_f32_32x32x16_bf16 a[112:127], a[244:247], a[252:255], a[112:127]
buffer_load_dwordx4 a[236:239], v243, s[24:27], s66 offen offset:0 sc1
v_cvt_pk_bf16_f32 v115, v134, v135
v_exp_f32 v137, v137
v_exp_f32 v138, v138
v_mfma_f32_32x32x16_bf16 a[32:47], v[104:107], v[112:115], a[32:47]
v_cvt_pk_bf16_f32 v116, v136, v137
v_exp_f32 v139, v139
v_exp_f32 v140, v140
v_cvt_pk_bf16_f32 v117, v138, v139
v_mfma_f32_32x32x16_bf16 a[64:79], a[128:131], a[136:139], a[64:79]
buffer_load_dwordx4 a[240:243], v240, s[24:27], s65 offen offset:2048 sc1
v_exp_f32 v141, v141
v_exp_f32 v142, v142
v_cvt_pk_bf16_f32 v118, v140, v141
v_exp_f32 v143, v143
v_mfma_f32_32x32x16_bf16 a[80:95], a[132:135], a[136:139], a[80:95]
buffer_load_dwordx4 a[248:251], v242, s[24:27], s66 offen offset:2048 sc1
v_exp_f32 v144, v144
v_cvt_pk_bf16_f32 v119, v142, v143
v_exp_f32 v145, v145
v_exp_f32 v146, v146
v_mfma_f32_32x32x16_bf16 a[32:47], v[108:111], v[116:119], a[32:47]
s_waitcnt vmcnt(33)
v_cvt_pk_bf16_f32 v112, v144, v145
v_exp_f32 v147, v147
v_exp_f32 v148, v148
v_cvt_pk_bf16_f32 v113, v146, v147
v_mfma_f32_32x32x16_bf16 v[128:143], v[48:51], v[16:19], 0
buffer_load_dwordx4 v[92:95], v0, s[16:19], s61 offen offset:3072 sc1
s_add_u32 s61, s61, 4096
v_exp_f32 v149, v149
v_exp_f32 v150, v150
v_cvt_pk_bf16_f32 v114, v148, v149
v_exp_f32 v151, v151
v_mfma_f32_32x32x16_bf16 v[128:143], v[52:55], v[20:23], v[128:143]
v_exp_f32 v152, v152
v_cvt_pk_bf16_f32 v115, v150, v151
v_exp_f32 v153, v153
v_exp_f32 v154, v154
v_mfma_f32_32x32x16_bf16 a[48:63], v[104:107], v[112:115], a[48:63]
v_cvt_pk_bf16_f32 v116, v152, v153
v_exp_f32 v155, v155
v_exp_f32 v156, v156
v_cvt_pk_bf16_f32 v117, v154, v155
v_mfma_f32_32x32x16_bf16 a[96:111], a[128:131], a[140:143], a[96:111]
buffer_load_dwordx4 a[244:247], v241, s[24:27], s65 offen offset:2048 sc1
s_add_u32 s65, s65, 4096
v_exp_f32 v157, v157
v_exp_f32 v158, v158
v_cvt_pk_bf16_f32 v118, v156, v157
v_exp_f32 v159, v159
v_mfma_f32_32x32x16_bf16 a[112:127], a[132:135], a[140:143], a[112:127]
buffer_load_dwordx4 a[252:255], v243, s[24:27], s66 offen offset:2048 sc1
s_add_u32 s66, s66, 4096
v_exp_f32 v128, v128
v_cvt_pk_bf16_f32 v119, v158, v159
v_exp_f32 v129, v129
v_exp_f32 v130, v130
v_mfma_f32_32x32x16_bf16 a[48:63], v[108:111], v[116:119], a[48:63]
s_waitcnt vmcnt(29)
v_cvt_pk_bf16_f32 v112, v128, v129
v_exp_f32 v131, v131
v_exp_f32 v132, v132
v_mfma_f32_32x32x16_bf16 v[144:159], v[48:51], v[24:27], 0
buffer_load_dwordx4 v[96:99], v0, s[16:19], s61 offen offset:0 sc1
v_cvt_pk_bf16_f32 v113, v130, v131
v_exp_f32 v133, v133
v_exp_f32 v134, v134
v_mfma_f32_32x32x16_bf16 v[144:159], v[52:55], v[28:31], v[144:159]
v_cvt_pk_bf16_f32 v114, v132, v133
v_exp_f32 v135, v135
v_exp_f32 v136, v136
v_mfma_f32_32x32x16_bf16 a[64:79], a[144:147], a[152:155], a[64:79]
buffer_load_dwordx4 a[128:131], v240, s[24:27], s65 offen offset:0 sc1
v_cvt_pk_bf16_f32 v115, v134, v135
v_exp_f32 v137, v137
v_exp_f32 v138, v138
v_mfma_f32_32x32x16_bf16 a[0:15], v[56:59], v[112:115], a[0:15]
v_cvt_pk_bf16_f32 v116, v136, v137
v_exp_f32 v139, v139
v_exp_f32 v140, v140
v_cvt_pk_bf16_f32 v117, v138, v139
v_mfma_f32_32x32x16_bf16 a[80:95], a[148:151], a[152:155], a[80:95]
buffer_load_dwordx4 a[136:139], v242, s[24:27], s66 offen offset:0 sc1
v_exp_f32 v141, v141
v_exp_f32 v142, v142
v_cvt_pk_bf16_f32 v118, v140, v141
v_exp_f32 v143, v143
v_mfma_f32_32x32x16_bf16 a[96:111], a[144:147], a[156:159], a[96:111]
buffer_load_dwordx4 a[132:135], v241, s[24:27], s65 offen offset:0 sc1
v_exp_f32 v144, v144
v_cvt_pk_bf16_f32 v119, v142, v143
v_exp_f32 v145, v145
v_exp_f32 v146, v146
v_mfma_f32_32x32x16_bf16 a[0:15], v[60:63], v[116:119], a[0:15]
s_waitcnt vmcnt(32)
v_cvt_pk_bf16_f32 v112, v144, v145
v_exp_f32 v147, v147
v_exp_f32 v148, v148
v_cvt_pk_bf16_f32 v113, v146, v147
v_mfma_f32_32x32x16_bf16 v[128:143], v[48:51], v[32:35], 0
buffer_load_dwordx4 v[100:103], v0, s[16:19], s61 offen offset:1024 sc1
v_exp_f32 v149, v149
v_exp_f32 v150, v150
v_cvt_pk_bf16_f32 v114, v148, v149
v_exp_f32 v151, v151
v_mfma_f32_32x32x16_bf16 v[128:143], v[52:55], v[36:39], v[128:143]
v_exp_f32 v152, v152
v_cvt_pk_bf16_f32 v115, v150, v151
v_exp_f32 v153, v153
v_exp_f32 v154, v154
v_mfma_f32_32x32x16_bf16 a[16:31], v[56:59], v[112:115], a[16:31]
v_cvt_pk_bf16_f32 v116, v152, v153
v_exp_f32 v155, v155
v_exp_f32 v156, v156
v_cvt_pk_bf16_f32 v117, v154, v155
v_mfma_f32_32x32x16_bf16 a[112:127], a[148:151], a[156:159], a[112:127]
buffer_load_dwordx4 a[140:143], v243, s[24:27], s66 offen offset:0 sc1
v_exp_f32 v157, v157
v_exp_f32 v158, v158
v_cvt_pk_bf16_f32 v118, v156, v157
v_exp_f32 v159, v159
v_mfma_f32_32x32x16_bf16 a[64:79], a[160:163], a[168:171], a[64:79]
buffer_load_dwordx4 a[144:147], v240, s[24:27], s65 offen offset:2048 sc1
v_exp_f32 v128, v128
v_cvt_pk_bf16_f32 v119, v158, v159
v_exp_f32 v129, v129
v_exp_f32 v130, v130
v_mfma_f32_32x32x16_bf16 a[16:31], v[60:63], v[116:119], a[16:31]
v_cvt_pk_bf16_f32 v112, v128, v129
v_exp_f32 v131, v131
v_exp_f32 v132, v132
v_cvt_pk_bf16_f32 v113, v130, v131
v_mfma_f32_32x32x16_bf16 v[144:159], v[48:51], v[40:43], 0
buffer_load_dwordx4 v[104:107], v0, s[16:19], s61 offen offset:2048 sc1
v_exp_f32 v133, v133
v_exp_f32 v134, v134
v_cvt_pk_bf16_f32 v114, v132, v133
v_exp_f32 v135, v135
v_mfma_f32_32x32x16_bf16 v[144:159], v[52:55], v[44:47], v[144:159]
v_exp_f32 v136, v136
v_cvt_pk_bf16_f32 v115, v134, v135
v_exp_f32 v137, v137
v_exp_f32 v138, v138
v_mfma_f32_32x32x16_bf16 a[32:47], v[56:59], v[112:115], a[32:47]
v_cvt_pk_bf16_f32 v116, v136, v137
v_exp_f32 v139, v139
v_exp_f32 v140, v140
v_cvt_pk_bf16_f32 v117, v138, v139
v_mfma_f32_32x32x16_bf16 a[80:95], a[164:167], a[168:171], a[80:95]
buffer_load_dwordx4 a[152:155], v242, s[24:27], s66 offen offset:2048 sc1
v_exp_f32 v141, v141
v_exp_f32 v142, v142
v_cvt_pk_bf16_f32 v118, v140, v141
v_exp_f32 v143, v143
v_mfma_f32_32x32x16_bf16 a[96:111], a[160:163], a[172:175], a[96:111]
buffer_load_dwordx4 a[148:151], v241, s[24:27], s65 offen offset:2048 sc1
s_add_u32 s65, s65, 4096
v_exp_f32 v144, v144
v_cvt_pk_bf16_f32 v119, v142, v143
v_exp_f32 v145, v145
v_exp_f32 v146, v146
v_mfma_f32_32x32x16_bf16 a[32:47], v[60:63], v[116:119], a[32:47]
s_waitcnt vmcnt(32)
v_cvt_pk_bf16_f32 v112, v144, v145
v_exp_f32 v147, v147
v_exp_f32 v148, v148
v_mfma_f32_32x32x16_bf16 v[128:143], v[64:67], v[16:19], 0
buffer_load_dwordx4 v[108:111], v0, s[16:19], s61 offen offset:3072 sc1
s_add_u32 s61, s61, 4096
v_cvt_pk_bf16_f32 v113, v146, v147
v_exp_f32 v149, v149
v_exp_f32 v150, v150
v_mfma_f32_32x32x16_bf16 v[128:143], v[68:71], v[20:23], v[128:143]
v_cvt_pk_bf16_f32 v114, v148, v149
v_exp_f32 v151, v151
v_exp_f32 v152, v152
v_mfma_f32_32x32x16_bf16 a[112:127], a[164:167], a[172:175], a[112:127]
buffer_load_dwordx4 a[156:159], v243, s[24:27], s66 offen offset:2048 sc1
s_add_u32 s66, s66, 4096
v_cvt_pk_bf16_f32 v115, v150, v151
v_exp_f32 v153, v153
v_exp_f32 v154, v154
v_mfma_f32_32x32x16_bf16 a[48:63], v[56:59], v[112:115], a[48:63]
v_cvt_pk_bf16_f32 v116, v152, v153
v_exp_f32 v155, v155
v_exp_f32 v156, v156
v_cvt_pk_bf16_f32 v117, v154, v155
v_mfma_f32_32x32x16_bf16 a[64:79], a[176:179], a[184:187], a[64:79]
buffer_load_dwordx4 a[160:163], v240, s[24:27], s65 offen offset:0 sc1
v_exp_f32 v157, v157
v_exp_f32 v158, v158
v_cvt_pk_bf16_f32 v118, v156, v157
v_exp_f32 v159, v159
v_mfma_f32_32x32x16_bf16 a[80:95], a[180:183], a[184:187], a[80:95]
buffer_load_dwordx4 a[168:171], v242, s[24:27], s66 offen offset:0 sc1
v_exp_f32 v128, v128
v_cvt_pk_bf16_f32 v119, v158, v159
v_exp_f32 v129, v129
v_exp_f32 v130, v130
v_mfma_f32_32x32x16_bf16 a[48:63], v[60:63], v[116:119], a[48:63]
s_waitcnt vmcnt(30)
v_cvt_pk_bf16_f32 v112, v128, v129
v_exp_f32 v131, v131
v_exp_f32 v132, v132
v_cvt_pk_bf16_f32 v113, v130, v131
v_mfma_f32_32x32x16_bf16 v[144:159], v[64:67], v[24:27], 0
buffer_load_dwordx4 v[48:51], v0, s[16:19], s61 offen offset:0 sc1
v_exp_f32 v133, v133
v_exp_f32 v134, v134
v_cvt_pk_bf16_f32 v114, v132, v133
v_exp_f32 v135, v135
v_mfma_f32_32x32x16_bf16 v[144:159], v[68:71], v[28:31], v[144:159]
v_exp_f32 v136, v136
v_cvt_pk_bf16_f32 v115, v134, v135
v_exp_f32 v137, v137
v_exp_f32 v138, v138
v_mfma_f32_32x32x16_bf16 a[0:15], v[72:75], v[112:115], a[0:15]
v_cvt_pk_bf16_f32 v116, v136, v137
v_exp_f32 v139, v139
v_exp_f32 v140, v140
v_cvt_pk_bf16_f32 v117, v138, v139
v_mfma_f32_32x32x16_bf16 a[96:111], a[176:179], a[188:191], a[96:111]
buffer_load_dwordx4 a[164:167], v241, s[24:27], s65 offen offset:0 sc1
v_exp_f32 v141, v141
v_exp_f32 v142, v142
v_cvt_pk_bf16_f32 v118, v140, v141
v_exp_f32 v143, v143
v_mfma_f32_32x32x16_bf16 a[112:127], a[180:183], a[188:191], a[112:127]
buffer_load_dwordx4 a[172:175], v243, s[24:27], s66 offen offset:0 sc1
v_exp_f32 v144, v144
v_cvt_pk_bf16_f32 v119, v142, v143
v_exp_f32 v145, v145
v_exp_f32 v146, v146
v_mfma_f32_32x32x16_bf16 a[0:15], v[76:79], v[116:119], a[0:15]
v_cvt_pk_bf16_f32 v112, v144, v145
v_exp_f32 v147, v147
v_exp_f32 v148, v148
v_mfma_f32_32x32x16_bf16 v[128:143], v[64:67], v[32:35], 0
buffer_load_dwordx4 v[52:55], v0, s[16:19], s61 offen offset:1024 sc1
v_cvt_pk_bf16_f32 v113, v146, v147
v_exp_f32 v149, v149
v_exp_f32 v150, v150
v_mfma_f32_32x32x16_bf16 v[128:143], v[68:71], v[36:39], v[128:143]
v_cvt_pk_bf16_f32 v114, v148, v149
v_exp_f32 v151, v151
v_exp_f32 v152, v152
v_mfma_f32_32x32x16_bf16 a[64:79], a[192:195], a[200:203], a[64:79]
buffer_load_dwordx4 a[176:179], v240, s[24:27], s65 offen offset:2048 sc1
v_cvt_pk_bf16_f32 v115, v150, v151
v_exp_f32 v153, v153
v_exp_f32 v154, v154
v_mfma_f32_32x32x16_bf16 a[16:31], v[72:75], v[112:115], a[16:31]
v_cvt_pk_bf16_f32 v116, v152, v153
v_exp_f32 v155, v155
v_exp_f32 v156, v156
v_cvt_pk_bf16_f32 v117, v154, v155
v_mfma_f32_32x32x16_bf16 a[80:95], a[196:199], a[200:203], a[80:95]
buffer_load_dwordx4 a[184:187], v242, s[24:27], s66 offen offset:2048 sc1
v_exp_f32 v157, v157
v_exp_f32 v158, v158
v_cvt_pk_bf16_f32 v118, v156, v157
v_exp_f32 v159, v159
v_mfma_f32_32x32x16_bf16 a[96:111], a[192:195], a[204:207], a[96:111]
buffer_load_dwordx4 a[180:183], v241, s[24:27], s65 offen offset:2048 sc1
s_add_u32 s65, s65, 4096
v_exp_f32 v128, v128
v_cvt_pk_bf16_f32 v119, v158, v159
v_exp_f32 v129, v129
v_exp_f32 v130, v130
v_mfma_f32_32x32x16_bf16 a[16:31], v[76:79], v[116:119], a[16:31]
s_waitcnt vmcnt(32)
v_cvt_pk_bf16_f32 v112, v128, v129
v_exp_f32 v131, v131
v_exp_f32 v132, v132
v_cvt_pk_bf16_f32 v113, v130, v131
v_mfma_f32_32x32x16_bf16 v[144:159], v[64:67], v[40:43], 0
buffer_load_dwordx4 v[56:59], v0, s[16:19], s61 offen offset:2048 sc1
v_exp_f32 v133, v133
v_exp_f32 v134, v134
v_cvt_pk_bf16_f32 v114, v132, v133
v_exp_f32 v135, v135
v_mfma_f32_32x32x16_bf16 v[144:159], v[68:71], v[44:47], v[144:159]
v_exp_f32 v136, v136
v_cvt_pk_bf16_f32 v115, v134, v135
v_exp_f32 v137, v137
v_exp_f32 v138, v138
v_mfma_f32_32x32x16_bf16 a[32:47], v[72:75], v[112:115], a[32:47]
v_cvt_pk_bf16_f32 v116, v136, v137
v_exp_f32 v139, v139
v_exp_f32 v140, v140
v_cvt_pk_bf16_f32 v117, v138, v139
v_mfma_f32_32x32x16_bf16 a[112:127], a[196:199], a[204:207], a[112:127]
buffer_load_dwordx4 a[188:191], v243, s[24:27], s66 offen offset:2048 sc1
s_add_u32 s66, s66, 4096
v_exp_f32 v141, v141
v_exp_f32 v142, v142
v_cvt_pk_bf16_f32 v118, v140, v141
v_exp_f32 v143, v143
v_mfma_f32_32x32x16_bf16 a[64:79], a[208:211], a[216:219], a[64:79]
buffer_load_dwordx4 a[192:195], v240, s[24:27], s65 offen offset:0 sc1
v_exp_f32 v144, v144
v_cvt_pk_bf16_f32 v119, v142, v143
v_exp_f32 v145, v145
v_exp_f32 v146, v146
v_mfma_f32_32x32x16_bf16 a[32:47], v[76:79], v[116:119], a[32:47]
s_waitcnt vmcnt(33)
v_cvt_pk_bf16_f32 v112, v144, v145
v_exp_f32 v147, v147
v_exp_f32 v148, v148
v_cvt_pk_bf16_f32 v113, v146, v147
v_mfma_f32_32x32x16_bf16 v[128:143], v[80:83], v[16:19], 0
buffer_load_dwordx4 v[60:63], v0, s[16:19], s61 offen offset:3072 sc1
s_add_u32 s61, s61, 4096
v_exp_f32 v149, v149
v_exp_f32 v150, v150
v_cvt_pk_bf16_f32 v114, v148, v149
v_exp_f32 v151, v151
v_mfma_f32_32x32x16_bf16 v[128:143], v[84:87], v[20:23], v[128:143]
v_exp_f32 v152, v152
v_cvt_pk_bf16_f32 v115, v150, v151
v_exp_f32 v153, v153
v_exp_f32 v154, v154
v_mfma_f32_32x32x16_bf16 a[48:63], v[72:75], v[112:115], a[48:63]
v_cvt_pk_bf16_f32 v116, v152, v153
v_exp_f32 v155, v155
v_exp_f32 v156, v156
v_cvt_pk_bf16_f32 v117, v154, v155
v_mfma_f32_32x32x16_bf16 a[80:95], a[212:215], a[216:219], a[80:95]
buffer_load_dwordx4 a[200:203], v242, s[24:27], s66 offen offset:0 sc1
v_exp_f32 v157, v157
v_exp_f32 v158, v158
v_cvt_pk_bf16_f32 v118, v156, v157
v_exp_f32 v159, v159
v_mfma_f32_32x32x16_bf16 a[96:111], a[208:211], a[220:223], a[96:111]
buffer_load_dwordx4 a[196:199], v241, s[24:27], s65 offen offset:0 sc1
v_exp_f32 v128, v128
v_cvt_pk_bf16_f32 v119, v158, v159
v_exp_f32 v129, v129
v_exp_f32 v130, v130
v_mfma_f32_32x32x16_bf16 a[48:63], v[76:79], v[116:119], a[48:63]
s_waitcnt vmcnt(29)
v_cvt_pk_bf16_f32 v112, v128, v129
v_exp_f32 v131, v131
v_exp_f32 v132, v132
v_mfma_f32_32x32x16_bf16 v[144:159], v[80:83], v[24:27], 0
buffer_load_dwordx4 v[64:67], v0, s[16:19], s61 offen offset:0 sc1
v_cvt_pk_bf16_f32 v113, v130, v131
v_exp_f32 v133, v133
v_exp_f32 v134, v134
v_mfma_f32_32x32x16_bf16 v[144:159], v[84:87], v[28:31], v[144:159]
v_cvt_pk_bf16_f32 v114, v132, v133
v_exp_f32 v135, v135
v_exp_f32 v136, v136
v_mfma_f32_32x32x16_bf16 a[112:127], a[212:215], a[220:223], a[112:127]
buffer_load_dwordx4 a[204:207], v243, s[24:27], s66 offen offset:0 sc1
v_cvt_pk_bf16_f32 v115, v134, v135
v_exp_f32 v137, v137
v_exp_f32 v138, v138
v_mfma_f32_32x32x16_bf16 a[0:15], v[88:91], v[112:115], a[0:15]
v_cvt_pk_bf16_f32 v116, v136, v137
v_exp_f32 v139, v139
v_exp_f32 v140, v140
v_cvt_pk_bf16_f32 v117, v138, v139
v_mfma_f32_32x32x16_bf16 a[64:79], a[224:227], a[232:235], a[64:79]
buffer_load_dwordx4 a[208:211], v240, s[24:27], s65 offen offset:2048 sc1
v_exp_f32 v141, v141
v_exp_f32 v142, v142
v_cvt_pk_bf16_f32 v118, v140, v141
v_exp_f32 v143, v143
v_mfma_f32_32x32x16_bf16 a[80:95], a[228:231], a[232:235], a[80:95]
buffer_load_dwordx4 a[216:219], v242, s[24:27], s66 offen offset:2048 sc1
v_exp_f32 v144, v144
v_cvt_pk_bf16_f32 v119, v142, v143
v_exp_f32 v145, v145
v_exp_f32 v146, v146
v_mfma_f32_32x32x16_bf16 a[0:15], v[92:95], v[116:119], a[0:15]
v_cvt_pk_bf16_f32 v112, v144, v145
v_exp_f32 v147, v147
v_exp_f32 v148, v148
v_cvt_pk_bf16_f32 v113, v146, v147
v_mfma_f32_32x32x16_bf16 v[128:143], v[80:83], v[32:35], 0
buffer_load_dwordx4 v[68:71], v0, s[16:19], s61 offen offset:1024 sc1
v_exp_f32 v149, v149
v_exp_f32 v150, v150
v_cvt_pk_bf16_f32 v114, v148, v149
v_exp_f32 v151, v151
v_mfma_f32_32x32x16_bf16 v[128:143], v[84:87], v[36:39], v[128:143]
v_exp_f32 v152, v152
v_cvt_pk_bf16_f32 v115, v150, v151
v_exp_f32 v153, v153
v_exp_f32 v154, v154
v_mfma_f32_32x32x16_bf16 a[16:31], v[88:91], v[112:115], a[16:31]
v_cvt_pk_bf16_f32 v116, v152, v153
v_exp_f32 v155, v155
v_exp_f32 v156, v156
v_cvt_pk_bf16_f32 v117, v154, v155
v_mfma_f32_32x32x16_bf16 a[96:111], a[224:227], a[236:239], a[96:111]
buffer_load_dwordx4 a[212:215], v241, s[24:27], s65 offen offset:2048 sc1
s_add_u32 s65, s65, 4096
v_exp_f32 v157, v157
v_exp_f32 v158, v158
v_cvt_pk_bf16_f32 v118, v156, v157
v_exp_f32 v159, v159
v_mfma_f32_32x32x16_bf16 a[112:127], a[228:231], a[236:239], a[112:127]
buffer_load_dwordx4 a[220:223], v243, s[24:27], s66 offen offset:2048 sc1
s_add_u32 s66, s66, 4096
v_exp_f32 v128, v128
v_cvt_pk_bf16_f32 v119, v158, v159
v_exp_f32 v129, v129
v_exp_f32 v130, v130
v_mfma_f32_32x32x16_bf16 a[16:31], v[92:95], v[116:119], a[16:31]
s_waitcnt vmcnt(34)
v_cvt_pk_bf16_f32 v112, v128, v129
v_exp_f32 v131, v131
v_exp_f32 v132, v132
v_cvt_pk_bf16_f32 v113, v130, v131
v_mfma_f32_32x32x16_bf16 v[144:159], v[80:83], v[40:43], 0
buffer_load_dwordx4 v[72:75], v0, s[16:19], s61 offen offset:2048 sc1
v_exp_f32 v133, v133
v_exp_f32 v134, v134
v_cvt_pk_bf16_f32 v114, v132, v133
v_exp_f32 v135, v135
v_mfma_f32_32x32x16_bf16 v[144:159], v[84:87], v[44:47], v[144:159]
v_exp_f32 v136, v136
v_cvt_pk_bf16_f32 v115, v134, v135
v_exp_f32 v137, v137
v_exp_f32 v138, v138
v_mfma_f32_32x32x16_bf16 a[32:47], v[88:91], v[112:115], a[32:47]
v_cvt_pk_bf16_f32 v116, v136, v137
v_exp_f32 v139, v139
v_exp_f32 v140, v140
v_cvt_pk_bf16_f32 v117, v138, v139
v_mfma_f32_32x32x16_bf16 a[64:79], a[240:243], a[248:251], a[64:79]
buffer_load_dwordx4 a[224:227], v240, s[24:27], s65 offen offset:0 sc1
v_exp_f32 v141, v141
v_exp_f32 v142, v142
v_cvt_pk_bf16_f32 v118, v140, v141
v_exp_f32 v143, v143
v_mfma_f32_32x32x16_bf16 a[80:95], a[244:247], a[248:251], a[80:95]
buffer_load_dwordx4 a[232:235], v242, s[24:27], s66 offen offset:0 sc1
v_exp_f32 v144, v144
v_cvt_pk_bf16_f32 v119, v142, v143
v_exp_f32 v145, v145
v_exp_f32 v146, v146
v_mfma_f32_32x32x16_bf16 a[32:47], v[92:95], v[116:119], a[32:47]
s_waitcnt vmcnt(31)
v_cvt_pk_bf16_f32 v112, v144, v145
v_exp_f32 v147, v147
v_exp_f32 v148, v148
v_mfma_f32_32x32x16_bf16 v[128:143], v[96:99], v[16:19], 0
buffer_load_dwordx4 v[76:79], v0, s[16:19], s61 offen offset:3072 sc1
s_add_u32 s61, s61, 4096
v_cvt_pk_bf16_f32 v113, v146, v147
v_exp_f32 v149, v149
v_exp_f32 v150, v150
v_mfma_f32_32x32x16_bf16 v[128:143], v[100:103], v[20:23], v[128:143]
v_cvt_pk_bf16_f32 v114, v148, v149
v_exp_f32 v151, v151
v_exp_f32 v152, v152
v_mfma_f32_32x32x16_bf16 a[96:111], a[240:243], a[252:255], a[96:111]
buffer_load_dwordx4 a[228:231], v241, s[24:27], s65 offen offset:0 sc1
v_cvt_pk_bf16_f32 v115, v150, v151
v_exp_f32 v153, v153
v_exp_f32 v154, v154
v_mfma_f32_32x32x16_bf16 a[48:63], v[88:91], v[112:115], a[48:63]
v_cvt_pk_bf16_f32 v116, v152, v153
v_exp_f32 v155, v155
v_exp_f32 v156, v156
v_cvt_pk_bf16_f32 v117, v154, v155
v_mfma_f32_32x32x16_bf16 a[112:127], a[244:247], a[252:255], a[112:127]
buffer_load_dwordx4 a[236:239], v243, s[24:27], s66 offen offset:0 sc1
v_exp_f32 v157, v157
v_exp_f32 v158, v158
v_cvt_pk_bf16_f32 v118, v156, v157
v_exp_f32 v159, v159
v_mfma_f32_32x32x16_bf16 a[64:79], a[128:131], a[136:139], a[64:79]
buffer_load_dwordx4 a[240:243], v240, s[24:27], s65 offen offset:2048 sc1
v_exp_f32 v128, v128
v_cvt_pk_bf16_f32 v119, v158, v159
v_exp_f32 v129, v129
v_exp_f32 v130, v130
v_mfma_f32_32x32x16_bf16 a[48:63], v[92:95], v[116:119], a[48:63]
s_waitcnt vmcnt(30)
v_cvt_pk_bf16_f32 v112, v128, v129
v_exp_f32 v131, v131
v_exp_f32 v132, v132
v_cvt_pk_bf16_f32 v113, v130, v131
v_mfma_f32_32x32x16_bf16 v[144:159], v[96:99], v[24:27], 0
buffer_load_dwordx4 v[80:83], v0, s[16:19], s61 offen offset:0 sc1
v_exp_f32 v133, v133
v_exp_f32 v134, v134
v_cvt_pk_bf16_f32 v114, v132, v133
v_exp_f32 v135, v135
v_mfma_f32_32x32x16_bf16 v[144:159], v[100:103], v[28:31], v[144:159]
v_exp_f32 v136, v136
v_cvt_pk_bf16_f32 v115, v134, v135
v_exp_f32 v137, v137
v_exp_f32 v138, v138
v_mfma_f32_32x32x16_bf16 a[0:15], v[104:107], v[112:115], a[0:15]
v_cvt_pk_bf16_f32 v116, v136, v137
v_exp_f32 v139, v139
v_exp_f32 v140, v140
v_cvt_pk_bf16_f32 v117, v138, v139
v_mfma_f32_32x32x16_bf16 a[80:95], a[132:135], a[136:139], a[80:95]
buffer_load_dwordx4 a[248:251], v242, s[24:27], s66 offen offset:2048 sc1
v_exp_f32 v141, v141
v_exp_f32 v142, v142
v_cvt_pk_bf16_f32 v118, v140, v141
v_exp_f32 v143, v143
v_mfma_f32_32x32x16_bf16 a[96:111], a[128:131], a[140:143], a[96:111]
buffer_load_dwordx4 a[244:247], v241, s[24:27], s65 offen offset:2048 sc1
s_add_u32 s65, s65, 4096
v_exp_f32 v144, v144
v_cvt_pk_bf16_f32 v119, v142, v143
v_exp_f32 v145, v145
v_exp_f32 v146, v146
v_mfma_f32_32x32x16_bf16 a[0:15], v[108:111], v[116:119], a[0:15]
s_waitcnt vmcnt(32)
v_cvt_pk_bf16_f32 v112, v144, v145
v_exp_f32 v147, v147
v_exp_f32 v148, v148
v_mfma_f32_32x32x16_bf16 v[128:143], v[96:99], v[32:35], 0
buffer_load_dwordx4 v[84:87], v0, s[16:19], s61 offen offset:1024 sc1
v_cvt_pk_bf16_f32 v113, v146, v147
v_exp_f32 v149, v149
v_exp_f32 v150, v150
v_mfma_f32_32x32x16_bf16 v[128:143], v[100:103], v[36:39], v[128:143]
v_cvt_pk_bf16_f32 v114, v148, v149
v_exp_f32 v151, v151
v_exp_f32 v152, v152
v_mfma_f32_32x32x16_bf16 a[112:127], a[132:135], a[140:143], a[112:127]
buffer_load_dwordx4 a[252:255], v243, s[24:27], s66 offen offset:2048 sc1
s_add_u32 s66, s66, 4096
v_cvt_pk_bf16_f32 v115, v150, v151
v_exp_f32 v153, v153
v_exp_f32 v154, v154
v_mfma_f32_32x32x16_bf16 a[16:31], v[104:107], v[112:115], a[16:31]
v_cvt_pk_bf16_f32 v116, v152, v153
v_exp_f32 v155, v155
v_exp_f32 v156, v156
v_cvt_pk_bf16_f32 v117, v154, v155
v_mfma_f32_32x32x16_bf16 a[64:79], a[144:147], a[152:155], a[64:79]
buffer_load_dwordx4 a[128:131], v240, s[24:27], s65 offen offset:0 sc1
v_exp_f32 v157, v157
v_exp_f32 v158, v158
v_cvt_pk_bf16_f32 v118, v156, v157
v_exp_f32 v159, v159
v_mfma_f32_32x32x16_bf16 a[80:95], a[148:151], a[152:155], a[80:95]
buffer_load_dwordx4 a[136:139], v242, s[24:27], s66 offen offset:0 sc1
v_exp_f32 v128, v128
v_cvt_pk_bf16_f32 v119, v158, v159
v_exp_f32 v129, v129
v_exp_f32 v130, v130
v_mfma_f32_32x32x16_bf16 a[16:31], v[108:111], v[116:119], a[16:31]
v_cvt_pk_bf16_f32 v112, v128, v129
v_exp_f32 v131, v131
v_exp_f32 v132, v132
v_cvt_pk_bf16_f32 v113, v130, v131
v_mfma_f32_32x32x16_bf16 v[144:159], v[96:99], v[40:43], 0
buffer_load_dwordx4 v[88:91], v0, s[16:19], s61 offen offset:2048 sc1
v_exp_f32 v133, v133
v_exp_f32 v134, v134
v_cvt_pk_bf16_f32 v114, v132, v133
v_exp_f32 v135, v135
v_mfma_f32_32x32x16_bf16 v[144:159], v[100:103], v[44:47], v[144:159]
v_exp_f32 v136, v136
v_cvt_pk_bf16_f32 v115, v134, v135
v_exp_f32 v137, v137
v_exp_f32 v138, v138
v_mfma_f32_32x32x16_bf16 a[32:47], v[104:107], v[112:115], a[32:47]
v_cvt_pk_bf16_f32 v116, v136, v137
v_exp_f32 v139, v139
v_exp_f32 v140, v140
v_cvt_pk_bf16_f32 v117, v138, v139
v_mfma_f32_32x32x16_bf16 a[96:111], a[144:147], a[156:159], a[96:111]
buffer_load_dwordx4 a[132:135], v241, s[24:27], s65 offen offset:0 sc1
v_exp_f32 v141, v141
v_exp_f32 v142, v142
v_cvt_pk_bf16_f32 v118, v140, v141
v_exp_f32 v143, v143
v_mfma_f32_32x32x16_bf16 a[112:127], a[148:151], a[156:159], a[112:127]
buffer_load_dwordx4 a[140:143], v243, s[24:27], s66 offen offset:0 sc1
v_exp_f32 v144, v144
v_cvt_pk_bf16_f32 v119, v142, v143
v_exp_f32 v145, v145
v_exp_f32 v146, v146
v_mfma_f32_32x32x16_bf16 a[32:47], v[108:111], v[116:119], a[32:47]
s_waitcnt vmcnt(33)
v_cvt_pk_bf16_f32 v112, v144, v145
v_exp_f32 v147, v147
v_exp_f32 v148, v148
v_cvt_pk_bf16_f32 v113, v146, v147
v_mfma_f32_32x32x16_bf16 v[128:143], v[48:51], v[16:19], 0
buffer_load_dwordx4 v[92:95], v0, s[16:19], s61 offen offset:3072 sc1
s_add_u32 s61, s61, 4096
v_exp_f32 v149, v149
v_exp_f32 v150, v150
v_cvt_pk_bf16_f32 v114, v148, v149
v_exp_f32 v151, v151
v_mfma_f32_32x32x16_bf16 v[128:143], v[52:55], v[20:23], v[128:143]
v_exp_f32 v152, v152
v_cvt_pk_bf16_f32 v115, v150, v151
v_exp_f32 v153, v153
v_exp_f32 v154, v154
v_mfma_f32_32x32x16_bf16 a[48:63], v[104:107], v[112:115], a[48:63]
v_cvt_pk_bf16_f32 v116, v152, v153
v_exp_f32 v155, v155
v_exp_f32 v156, v156
v_cvt_pk_bf16_f32 v117, v154, v155
v_mfma_f32_32x32x16_bf16 a[64:79], a[160:163], a[168:171], a[64:79]
buffer_load_dwordx4 a[144:147], v240, s[24:27], s65 offen offset:2048 sc1
v_exp_f32 v157, v157
v_exp_f32 v158, v158
v_cvt_pk_bf16_f32 v118, v156, v157
v_exp_f32 v159, v159
v_mfma_f32_32x32x16_bf16 a[80:95], a[164:167], a[168:171], a[80:95]
buffer_load_dwordx4 a[152:155], v242, s[24:27], s66 offen offset:2048 sc1
v_exp_f32 v128, v128
v_cvt_pk_bf16_f32 v119, v158, v159
v_exp_f32 v129, v129
v_exp_f32 v130, v130
v_mfma_f32_32x32x16_bf16 a[48:63], v[108:111], v[116:119], a[48:63]
s_waitcnt vmcnt(29)
v_cvt_pk_bf16_f32 v112, v128, v129
v_exp_f32 v131, v131
v_exp_f32 v132, v132
v_mfma_f32_32x32x16_bf16 v[144:159], v[48:51], v[24:27], 0
buffer_load_dwordx4 v[96:99], v0, s[16:19], s61 offen offset:0 sc1
v_cvt_pk_bf16_f32 v113, v130, v131
v_exp_f32 v133, v133
v_exp_f32 v134, v134
v_mfma_f32_32x32x16_bf16 v[144:159], v[52:55], v[28:31], v[144:159]
v_cvt_pk_bf16_f32 v114, v132, v133
v_exp_f32 v135, v135
v_exp_f32 v136, v136
v_mfma_f32_32x32x16_bf16 a[96:111], a[160:163], a[172:175], a[96:111]
buffer_load_dwordx4 a[148:151], v241, s[24:27], s65 offen offset:2048 sc1
s_add_u32 s65, s65, 4096
v_cvt_pk_bf16_f32 v115, v134, v135
v_exp_f32 v137, v137
v_exp_f32 v138, v138
v_mfma_f32_32x32x16_bf16 a[0:15], v[56:59], v[112:115], a[0:15]
v_cvt_pk_bf16_f32 v116, v136, v137
v_exp_f32 v139, v139
v_exp_f32 v140, v140
v_cvt_pk_bf16_f32 v117, v138, v139
v_mfma_f32_32x32x16_bf16 a[112:127], a[164:167], a[172:175], a[112:127]
buffer_load_dwordx4 a[156:159], v243, s[24:27], s66 offen offset:2048 sc1
s_add_u32 s66, s66, 4096
v_exp_f32 v141, v141
v_exp_f32 v142, v142
v_cvt_pk_bf16_f32 v118, v140, v141
v_exp_f32 v143, v143
v_mfma_f32_32x32x16_bf16 a[64:79], a[176:179], a[184:187], a[64:79]
buffer_load_dwordx4 a[160:163], v240, s[24:27], s65 offen offset:0 sc1
v_exp_f32 v144, v144
v_cvt_pk_bf16_f32 v119, v142, v143
v_exp_f32 v145, v145
v_exp_f32 v146, v146
v_mfma_f32_32x32x16_bf16 a[0:15], v[60:63], v[116:119], a[0:15]
v_cvt_pk_bf16_f32 v112, v144, v145
v_exp_f32 v147, v147
v_exp_f32 v148, v148
v_cvt_pk_bf16_f32 v113, v146, v147
v_mfma_f32_32x32x16_bf16 v[128:143], v[48:51], v[32:35], 0
buffer_load_dwordx4 v[100:103], v0, s[16:19], s61 offen offset:1024 sc1
v_exp_f32 v149, v149
v_exp_f32 v150, v150
v_cvt_pk_bf16_f32 v114, v148, v149
v_exp_f32 v151, v151
v_mfma_f32_32x32x16_bf16 v[128:143], v[52:55], v[36:39], v[128:143]
v_exp_f32 v152, v152
v_cvt_pk_bf16_f32 v115, v150, v151
v_exp_f32 v153, v153
v_exp_f32 v154, v154
v_mfma_f32_32x32x16_bf16 a[16:31], v[56:59], v[112:115], a[16:31]
v_cvt_pk_bf16_f32 v116, v152, v153
v_exp_f32 v155, v155
v_exp_f32 v156, v156
v_cvt_pk_bf16_f32 v117, v154, v155
v_mfma_f32_32x32x16_bf16 a[80:95], a[180:183], a[184:187], a[80:95]
buffer_load_dwordx4 a[168:171], v242, s[24:27], s66 offen offset:0 sc1
v_exp_f32 v157, v157
v_exp_f32 v158, v158
v_cvt_pk_bf16_f32 v118, v156, v157
v_exp_f32 v159, v159
v_mfma_f32_32x32x16_bf16 a[96:111], a[176:179], a[188:191], a[96:111]
buffer_load_dwordx4 a[164:167], v241, s[24:27], s65 offen offset:0 sc1
v_exp_f32 v128, v128
v_cvt_pk_bf16_f32 v119, v158, v159
v_exp_f32 v129, v129
v_exp_f32 v130, v130
v_mfma_f32_32x32x16_bf16 a[16:31], v[60:63], v[116:119], a[16:31]
s_waitcnt vmcnt(32)
v_cvt_pk_bf16_f32 v112, v128, v129
v_exp_f32 v131, v131
v_exp_f32 v132, v132
v_mfma_f32_32x32x16_bf16 v[144:159], v[48:51], v[40:43], 0
buffer_load_dwordx4 v[104:107], v0, s[16:19], s61 offen offset:2048 sc1
v_cvt_pk_bf16_f32 v113, v130, v131
v_exp_f32 v133, v133
v_exp_f32 v134, v134
v_mfma_f32_32x32x16_bf16 v[144:159], v[52:55], v[44:47], v[144:159]
v_cvt_pk_bf16_f32 v114, v132, v133
v_exp_f32 v135, v135
v_exp_f32 v136, v136
v_mfma_f32_32x32x16_bf16 a[112:127], a[180:183], a[188:191], a[112:127]
buffer_load_dwordx4 a[172:175], v243, s[24:27], s66 offen offset:0 sc1
v_cvt_pk_bf16_f32 v115, v134, v135
v_exp_f32 v137, v137
v_exp_f32 v138, v138
v_mfma_f32_32x32x16_bf16 a[32:47], v[56:59], v[112:115], a[32:47]
v_cvt_pk_bf16_f32 v116, v136, v137
v_exp_f32 v139, v139
v_exp_f32 v140, v140
v_cvt_pk_bf16_f32 v117, v138, v139
v_mfma_f32_32x32x16_bf16 a[64:79], a[192:195], a[200:203], a[64:79]
buffer_load_dwordx4 a[176:179], v240, s[24:27], s65 offen offset:2048 sc1
v_exp_f32 v141, v141
v_exp_f32 v142, v142
v_cvt_pk_bf16_f32 v118, v140, v141
v_exp_f32 v143, v143
v_mfma_f32_32x32x16_bf16 a[80:95], a[196:199], a[200:203], a[80:95]
buffer_load_dwordx4 a[184:187], v242, s[24:27], s66 offen offset:2048 sc1
v_exp_f32 v144, v144
v_cvt_pk_bf16_f32 v119, v142, v143
v_exp_f32 v145, v145
v_exp_f32 v146, v146
v_mfma_f32_32x32x16_bf16 a[32:47], v[60:63], v[116:119], a[32:47]
s_waitcnt vmcnt(33)
v_cvt_pk_bf16_f32 v112, v144, v145
v_exp_f32 v147, v147
v_exp_f32 v148, v148
v_cvt_pk_bf16_f32 v113, v146, v147
v_mfma_f32_32x32x16_bf16 v[128:143], v[64:67], v[16:19], 0
buffer_load_dwordx4 v[108:111], v0, s[16:19], s61 offen offset:3072 sc1
s_add_u32 s61, s61, 4096
v_exp_f32 v149, v149
v_exp_f32 v150, v150
v_cvt_pk_bf16_f32 v114, v148, v149
v_exp_f32 v151, v151
v_mfma_f32_32x32x16_bf16 v[128:143], v[68:71], v[20:23], v[128:143]
v_exp_f32 v152, v152
v_cvt_pk_bf16_f32 v115, v150, v151
v_exp_f32 v153, v153
v_exp_f32 v154, v154
v_mfma_f32_32x32x16_bf16 a[48:63], v[56:59], v[112:115], a[48:63]
v_cvt_pk_bf16_f32 v116, v152, v153
v_exp_f32 v155, v155
v_exp_f32 v156, v156
v_cvt_pk_bf16_f32 v117, v154, v155
v_mfma_f32_32x32x16_bf16 a[96:111], a[192:195], a[204:207], a[96:111]
buffer_load_dwordx4 a[180:183], v241, s[24:27], s65 offen offset:2048 sc1
s_add_u32 s65, s65, 4096
v_exp_f32 v157, v157
v_exp_f32 v158, v158
v_cvt_pk_bf16_f32 v118, v156, v157
v_exp_f32 v159, v159
v_mfma_f32_32x32x16_bf16 a[112:127], a[196:199], a[204:207], a[112:127]
buffer_load_dwordx4 a[188:191], v243, s[24:27], s66 offen offset:2048 sc1
s_add_u32 s66, s66, 4096
v_exp_f32 v128, v128
v_cvt_pk_bf16_f32 v119, v158, v159
v_exp_f32 v129, v129
v_exp_f32 v130, v130
v_mfma_f32_32x32x16_bf16 a[48:63], v[60:63], v[116:119], a[48:63]
s_waitcnt vmcnt(30)
v_cvt_pk_bf16_f32 v112, v128, v129
v_exp_f32 v131, v131
v_exp_f32 v132, v132
v_cvt_pk_bf16_f32 v113, v130, v131
v_mfma_f32_32x32x16_bf16 v[144:159], v[64:67], v[24:27], 0
v_exp_f32 v133, v133
v_exp_f32 v134, v134
v_cvt_pk_bf16_f32 v114, v132, v133
v_exp_f32 v135, v135
v_mfma_f32_32x32x16_bf16 v[144:159], v[68:71], v[28:31], v[144:159]
v_exp_f32 v136, v136
v_cvt_pk_bf16_f32 v115, v134, v135
v_exp_f32 v137, v137
v_exp_f32 v138, v138
v_mfma_f32_32x32x16_bf16 a[0:15], v[72:75], v[112:115], a[0:15]
v_cvt_pk_bf16_f32 v116, v136, v137
v_exp_f32 v139, v139
v_exp_f32 v140, v140
v_cvt_pk_bf16_f32 v117, v138, v139
v_mfma_f32_32x32x16_bf16 a[64:79], a[208:211], a[216:219], a[64:79]
v_exp_f32 v141, v141
v_exp_f32 v142, v142
v_cvt_pk_bf16_f32 v118, v140, v141
v_exp_f32 v143, v143
v_mfma_f32_32x32x16_bf16 a[80:95], a[212:215], a[216:219], a[80:95]
v_exp_f32 v144, v144
v_cvt_pk_bf16_f32 v119, v142, v143
v_exp_f32 v145, v145
v_exp_f32 v146, v146
v_mfma_f32_32x32x16_bf16 a[0:15], v[76:79], v[116:119], a[0:15]
s_waitcnt vmcnt(28)
v_cvt_pk_bf16_f32 v112, v144, v145
v_exp_f32 v147, v147
v_exp_f32 v148, v148
v_mfma_f32_32x32x16_bf16 v[128:143], v[64:67], v[32:35], 0
v_cvt_pk_bf16_f32 v113, v146, v147
v_exp_f32 v149, v149
v_exp_f32 v150, v150
v_mfma_f32_32x32x16_bf16 v[128:143], v[68:71], v[36:39], v[128:143]
v_cvt_pk_bf16_f32 v114, v148, v149
v_exp_f32 v151, v151
v_exp_f32 v152, v152
v_mfma_f32_32x32x16_bf16 a[96:111], a[208:211], a[220:223], a[96:111]
v_cvt_pk_bf16_f32 v115, v150, v151
v_exp_f32 v153, v153
v_exp_f32 v154, v154
v_mfma_f32_32x32x16_bf16 a[16:31], v[72:75], v[112:115], a[16:31]
v_cvt_pk_bf16_f32 v116, v152, v153
v_exp_f32 v155, v155
v_exp_f32 v156, v156
v_cvt_pk_bf16_f32 v117, v154, v155
v_mfma_f32_32x32x16_bf16 a[112:127], a[212:215], a[220:223], a[112:127]
v_exp_f32 v157, v157
v_exp_f32 v158, v158
v_cvt_pk_bf16_f32 v118, v156, v157
v_exp_f32 v159, v159
v_mfma_f32_32x32x16_bf16 a[64:79], a[224:227], a[232:235], a[64:79]
v_exp_f32 v128, v128
v_cvt_pk_bf16_f32 v119, v158, v159
v_exp_f32 v129, v129
v_exp_f32 v130, v130
v_mfma_f32_32x32x16_bf16 a[16:31], v[76:79], v[116:119], a[16:31]
v_cvt_pk_bf16_f32 v112, v128, v129
v_exp_f32 v131, v131
v_exp_f32 v132, v132
v_cvt_pk_bf16_f32 v113, v130, v131
v_mfma_f32_32x32x16_bf16 v[144:159], v[64:67], v[40:43], 0
v_exp_f32 v133, v133
v_exp_f32 v134, v134
v_cvt_pk_bf16_f32 v114, v132, v133
v_exp_f32 v135, v135
v_mfma_f32_32x32x16_bf16 v[144:159], v[68:71], v[44:47], v[144:159]
v_exp_f32 v136, v136
v_cvt_pk_bf16_f32 v115, v134, v135
v_exp_f32 v137, v137
v_exp_f32 v138, v138
v_mfma_f32_32x32x16_bf16 a[32:47], v[72:75], v[112:115], a[32:47]
v_cvt_pk_bf16_f32 v116, v136, v137
v_exp_f32 v139, v139
v_exp_f32 v140, v140
v_cvt_pk_bf16_f32 v117, v138, v139
v_mfma_f32_32x32x16_bf16 a[80:95], a[228:231], a[232:235], a[80:95]
v_exp_f32 v141, v141
v_exp_f32 v142, v142
v_cvt_pk_bf16_f32 v118, v140, v141
v_exp_f32 v143, v143
v_mfma_f32_32x32x16_bf16 a[96:111], a[224:227], a[236:239], a[96:111]
v_exp_f32 v144, v144
v_cvt_pk_bf16_f32 v119, v142, v143
v_exp_f32 v145, v145
v_exp_f32 v146, v146
v_mfma_f32_32x32x16_bf16 a[32:47], v[76:79], v[116:119], a[32:47]
s_waitcnt vmcnt(22)
v_cvt_pk_bf16_f32 v112, v144, v145
v_exp_f32 v147, v147
v_exp_f32 v148, v148
v_cvt_pk_bf16_f32 v113, v146, v147
v_mfma_f32_32x32x16_bf16 v[128:143], v[80:83], v[16:19], 0
v_exp_f32 v149, v149
v_exp_f32 v150, v150
v_cvt_pk_bf16_f32 v114, v148, v149
v_exp_f32 v151, v151
v_mfma_f32_32x32x16_bf16 v[128:143], v[84:87], v[20:23], v[128:143]
v_exp_f32 v152, v152
v_cvt_pk_bf16_f32 v115, v150, v151
v_exp_f32 v153, v153
v_exp_f32 v154, v154
v_mfma_f32_32x32x16_bf16 a[48:63], v[72:75], v[112:115], a[48:63]
v_cvt_pk_bf16_f32 v116, v152, v153
v_exp_f32 v155, v155
v_exp_f32 v156, v156
v_cvt_pk_bf16_f32 v117, v154, v155
v_mfma_f32_32x32x16_bf16 a[112:127], a[228:231], a[236:239], a[112:127]
v_exp_f32 v157, v157
v_exp_f32 v158, v158
v_cvt_pk_bf16_f32 v118, v156, v157
v_exp_f32 v159, v159
v_mfma_f32_32x32x16_bf16 a[64:79], a[240:243], a[248:251], a[64:79]
v_exp_f32 v128, v128
v_cvt_pk_bf16_f32 v119, v158, v159
v_exp_f32 v129, v129
v_exp_f32 v130, v130
v_mfma_f32_32x32x16_bf16 a[48:63], v[76:79], v[116:119], a[48:63]
s_waitcnt vmcnt(16)
v_cvt_pk_bf16_f32 v112, v128, v129
v_exp_f32 v131, v131
v_exp_f32 v132, v132
v_mfma_f32_32x32x16_bf16 v[144:159], v[80:83], v[24:27], 0
v_cvt_pk_bf16_f32 v113, v130, v131
v_exp_f32 v133, v133
v_exp_f32 v134, v134
v_mfma_f32_32x32x16_bf16 v[144:159], v[84:87], v[28:31], v[144:159]
v_cvt_pk_bf16_f32 v114, v132, v133
v_exp_f32 v135, v135
v_exp_f32 v136, v136
v_mfma_f32_32x32x16_bf16 a[80:95], a[244:247], a[248:251], a[80:95]
v_cvt_pk_bf16_f32 v115, v134, v135
v_exp_f32 v137, v137
v_exp_f32 v138, v138
v_mfma_f32_32x32x16_bf16 a[0:15], v[88:91], v[112:115], a[0:15]
v_cvt_pk_bf16_f32 v116, v136, v137
v_exp_f32 v139, v139
v_exp_f32 v140, v140
v_cvt_pk_bf16_f32 v117, v138, v139
v_mfma_f32_32x32x16_bf16 a[96:111], a[240:243], a[252:255], a[96:111]
v_exp_f32 v141, v141
v_exp_f32 v142, v142
v_cvt_pk_bf16_f32 v118, v140, v141
v_exp_f32 v143, v143
v_mfma_f32_32x32x16_bf16 a[112:127], a[244:247], a[252:255], a[112:127]
v_exp_f32 v144, v144
v_cvt_pk_bf16_f32 v119, v142, v143
v_exp_f32 v145, v145
v_exp_f32 v146, v146
v_mfma_f32_32x32x16_bf16 a[0:15], v[92:95], v[116:119], a[0:15]
v_cvt_pk_bf16_f32 v112, v144, v145
v_exp_f32 v147, v147
v_exp_f32 v148, v148
v_cvt_pk_bf16_f32 v113, v146, v147
v_mfma_f32_32x32x16_bf16 v[128:143], v[80:83], v[32:35], 0
v_exp_f32 v149, v149
v_exp_f32 v150, v150
v_cvt_pk_bf16_f32 v114, v148, v149
v_exp_f32 v151, v151
v_mfma_f32_32x32x16_bf16 v[128:143], v[84:87], v[36:39], v[128:143]
v_exp_f32 v152, v152
v_cvt_pk_bf16_f32 v115, v150, v151
v_exp_f32 v153, v153
v_exp_f32 v154, v154
v_mfma_f32_32x32x16_bf16 a[16:31], v[88:91], v[112:115], a[16:31]
v_cvt_pk_bf16_f32 v116, v152, v153
v_exp_f32 v155, v155
v_exp_f32 v156, v156
v_cvt_pk_bf16_f32 v117, v154, v155
v_mfma_f32_32x32x16_bf16 a[64:79], a[128:131], a[136:139], a[64:79]
v_exp_f32 v157, v157
v_exp_f32 v158, v158
v_cvt_pk_bf16_f32 v118, v156, v157
v_exp_f32 v159, v159
v_mfma_f32_32x32x16_bf16 a[80:95], a[132:135], a[136:139], a[80:95]
v_exp_f32 v128, v128
v_cvt_pk_bf16_f32 v119, v158, v159
v_exp_f32 v129, v129
v_exp_f32 v130, v130
v_mfma_f32_32x32x16_bf16 a[16:31], v[92:95], v[116:119], a[16:31]
s_waitcnt vmcnt(11)
v_cvt_pk_bf16_f32 v112, v128, v129
v_exp_f32 v131, v131
v_exp_f32 v132, v132
v_mfma_f32_32x32x16_bf16 v[144:159], v[80:83], v[40:43], 0
v_cvt_pk_bf16_f32 v113, v130, v131
v_exp_f32 v133, v133
v_exp_f32 v134, v134
v_mfma_f32_32x32x16_bf16 v[144:159], v[84:87], v[44:47], v[144:159]
v_cvt_pk_bf16_f32 v114, v132, v133
v_exp_f32 v135, v135
v_exp_f32 v136, v136
v_mfma_f32_32x32x16_bf16 a[96:111], a[128:131], a[140:143], a[96:111]
v_cvt_pk_bf16_f32 v115, v134, v135
v_exp_f32 v137, v137
v_exp_f32 v138, v138
v_mfma_f32_32x32x16_bf16 a[32:47], v[88:91], v[112:115], a[32:47]
buffer_load_dwordx2 v[120:121], v248, s[4:7], 0 offen offset:0
v_cvt_pk_bf16_f32 v116, v136, v137
v_exp_f32 v139, v139
v_exp_f32 v140, v140
v_cvt_pk_bf16_f32 v117, v138, v139
v_mfma_f32_32x32x16_bf16 a[112:127], a[132:135], a[140:143], a[112:127]
v_exp_f32 v141, v141
v_exp_f32 v142, v142
v_cvt_pk_bf16_f32 v118, v140, v141
v_exp_f32 v143, v143
v_mfma_f32_32x32x16_bf16 a[64:79], a[144:147], a[152:155], a[64:79]
v_exp_f32 v144, v144
v_cvt_pk_bf16_f32 v119, v142, v143
v_exp_f32 v145, v145
v_exp_f32 v146, v146
v_mfma_f32_32x32x16_bf16 a[32:47], v[92:95], v[116:119], a[32:47]
s_waitcnt vmcnt(10)
v_cvt_pk_bf16_f32 v112, v144, v145
v_exp_f32 v147, v147
v_exp_f32 v148, v148
v_cvt_pk_bf16_f32 v113, v146, v147
v_mfma_f32_32x32x16_bf16 v[128:143], v[96:99], v[16:19], 0
v_exp_f32 v149, v149
v_exp_f32 v150, v150
v_cvt_pk_bf16_f32 v114, v148, v149
v_exp_f32 v151, v151
v_mfma_f32_32x32x16_bf16 v[128:143], v[100:103], v[20:23], v[128:143]
v_exp_f32 v152, v152
v_cvt_pk_bf16_f32 v115, v150, v151
v_exp_f32 v153, v153
v_exp_f32 v154, v154
v_mfma_f32_32x32x16_bf16 a[48:63], v[88:91], v[112:115], a[48:63]
buffer_load_dwordx2 v[122:123], v248, s[4:7], 0 offen offset:16
v_cvt_pk_bf16_f32 v116, v152, v153
v_exp_f32 v155, v155
v_exp_f32 v156, v156
v_cvt_pk_bf16_f32 v117, v154, v155
v_mfma_f32_32x32x16_bf16 a[80:95], a[148:151], a[152:155], a[80:95]
v_exp_f32 v157, v157
v_exp_f32 v158, v158
v_cvt_pk_bf16_f32 v118, v156, v157
v_exp_f32 v159, v159
v_mfma_f32_32x32x16_bf16 a[96:111], a[144:147], a[156:159], a[96:111]
v_exp_f32 v128, v128
v_cvt_pk_bf16_f32 v119, v158, v159
v_exp_f32 v129, v129
v_exp_f32 v130, v130
v_mfma_f32_32x32x16_bf16 a[48:63], v[92:95], v[116:119], a[48:63]
s_waitcnt vmcnt(4)
v_cvt_pk_bf16_f32 v112, v128, v129
v_exp_f32 v131, v131
v_exp_f32 v132, v132
v_cvt_pk_bf16_f32 v113, v130, v131
v_mfma_f32_32x32x16_bf16 v[144:159], v[96:99], v[24:27], 0
v_exp_f32 v133, v133
v_exp_f32 v134, v134
v_cvt_pk_bf16_f32 v114, v132, v133
v_exp_f32 v135, v135
v_mfma_f32_32x32x16_bf16 v[144:159], v[100:103], v[28:31], v[144:159]
v_exp_f32 v136, v136
v_cvt_pk_bf16_f32 v115, v134, v135
v_exp_f32 v137, v137
v_exp_f32 v138, v138
v_mfma_f32_32x32x16_bf16 a[0:15], v[104:107], v[112:115], a[0:15]
buffer_load_dwordx2 v[124:125], v248, s[4:7], 0 offen offset:32
v_cvt_pk_bf16_f32 v116, v136, v137
v_exp_f32 v139, v139
v_exp_f32 v140, v140
v_cvt_pk_bf16_f32 v117, v138, v139
v_mfma_f32_32x32x16_bf16 a[112:127], a[148:151], a[156:159], a[112:127]
v_exp_f32 v141, v141
v_exp_f32 v142, v142
v_cvt_pk_bf16_f32 v118, v140, v141
v_exp_f32 v143, v143
v_mfma_f32_32x32x16_bf16 a[64:79], a[160:163], a[168:171], a[64:79]
v_exp_f32 v144, v144
v_cvt_pk_bf16_f32 v119, v142, v143
v_exp_f32 v145, v145
v_exp_f32 v146, v146
v_mfma_f32_32x32x16_bf16 a[0:15], v[108:111], v[116:119], a[0:15]
v_cvt_pk_bf16_f32 v112, v144, v145
v_exp_f32 v147, v147
v_exp_f32 v148, v148
v_mfma_f32_32x32x16_bf16 v[128:143], v[96:99], v[32:35], 0
v_cvt_pk_bf16_f32 v113, v146, v147
v_exp_f32 v149, v149
v_exp_f32 v150, v150
v_mfma_f32_32x32x16_bf16 v[128:143], v[100:103], v[36:39], v[128:143]
v_cvt_pk_bf16_f32 v114, v148, v149
v_exp_f32 v151, v151
v_exp_f32 v152, v152
v_mfma_f32_32x32x16_bf16 a[80:95], a[164:167], a[168:171], a[80:95]
v_cvt_pk_bf16_f32 v115, v150, v151
v_exp_f32 v153, v153
v_exp_f32 v154, v154
v_mfma_f32_32x32x16_bf16 a[16:31], v[104:107], v[112:115], a[16:31]
buffer_load_dwordx2 v[126:127], v248, s[4:7], 0 offen offset:48
v_cvt_pk_bf16_f32 v116, v152, v153
v_exp_f32 v155, v155
v_exp_f32 v156, v156
v_cvt_pk_bf16_f32 v117, v154, v155
v_mfma_f32_32x32x16_bf16 a[96:111], a[160:163], a[172:175], a[96:111]
v_exp_f32 v157, v157
v_exp_f32 v158, v158
v_cvt_pk_bf16_f32 v118, v156, v157
v_exp_f32 v159, v159
v_mfma_f32_32x32x16_bf16 a[112:127], a[164:167], a[172:175], a[112:127]
v_exp_f32 v128, v128
v_cvt_pk_bf16_f32 v119, v158, v159
v_exp_f32 v129, v129
v_exp_f32 v130, v130
v_mfma_f32_32x32x16_bf16 a[16:31], v[108:111], v[116:119], a[16:31]
s_waitcnt vmcnt(4)
v_cvt_pk_bf16_f32 v112, v128, v129
v_exp_f32 v131, v131
v_exp_f32 v132, v132
v_cvt_pk_bf16_f32 v113, v130, v131
v_mfma_f32_32x32x16_bf16 v[144:159], v[96:99], v[40:43], 0
v_exp_f32 v133, v133
v_exp_f32 v134, v134
v_cvt_pk_bf16_f32 v114, v132, v133
v_exp_f32 v135, v135
v_mfma_f32_32x32x16_bf16 v[144:159], v[100:103], v[44:47], v[144:159]
v_exp_f32 v136, v136
v_cvt_pk_bf16_f32 v115, v134, v135
v_exp_f32 v137, v137
v_exp_f32 v138, v138
v_mfma_f32_32x32x16_bf16 a[32:47], v[104:107], v[112:115], a[32:47]
v_cvt_pk_bf16_f32 v116, v136, v137
v_exp_f32 v139, v139
v_exp_f32 v140, v140
v_cvt_pk_bf16_f32 v117, v138, v139
v_mfma_f32_32x32x16_bf16 a[64:79], a[176:179], a[184:187], a[64:79]
v_exp_f32 v141, v141
v_exp_f32 v142, v142
v_cvt_pk_bf16_f32 v118, v140, v141
v_exp_f32 v143, v143
v_mfma_f32_32x32x16_bf16 a[80:95], a[180:183], a[184:187], a[80:95]
v_exp_f32 v144, v144
v_cvt_pk_bf16_f32 v119, v142, v143
v_exp_f32 v145, v145
v_exp_f32 v146, v146
v_mfma_f32_32x32x16_bf16 a[32:47], v[108:111], v[116:119], a[32:47]
v_cvt_pk_bf16_f32 v112, v144, v145
v_exp_f32 v147, v147
v_exp_f32 v148, v148
v_cvt_pk_bf16_f32 v113, v146, v147
v_exp_f32 v149, v149
v_exp_f32 v150, v150
v_cvt_pk_bf16_f32 v114, v148, v149
v_exp_f32 v151, v151
v_exp_f32 v152, v152
v_cvt_pk_bf16_f32 v115, v150, v151
v_exp_f32 v153, v153
v_exp_f32 v154, v154
v_mfma_f32_32x32x16_bf16 a[48:63], v[104:107], v[112:115], a[48:63]
v_cvt_pk_bf16_f32 v116, v152, v153
v_exp_f32 v155, v155
v_exp_f32 v156, v156
v_cvt_pk_bf16_f32 v117, v154, v155
v_mfma_f32_32x32x16_bf16 a[96:111], a[176:179], a[188:191], a[96:111]
v_exp_f32 v157, v157
v_exp_f32 v158, v158
v_cvt_pk_bf16_f32 v118, v156, v157
v_exp_f32 v159, v159
v_mfma_f32_32x32x16_bf16 a[112:127], a[180:183], a[188:191], a[112:127]
v_cvt_pk_bf16_f32 v119, v158, v159
s_nop 1
v_mfma_f32_32x32x16_bf16 a[48:63], v[108:111], v[116:119], a[48:63]
ds_write_b128 v244, a[16:19] offset:49152
ds_write_b128 v244, a[20:23] offset:50176
ds_write_b128 v244, a[24:27] offset:51200
ds_write_b128 v244, a[28:31] offset:52224
ds_write_b128 v245, a[32:35] offset:49152
ds_write_b128 v245, a[36:39] offset:50176
ds_write_b128 v245, a[40:43] offset:51200
ds_write_b128 v245, a[44:47] offset:52224
s_nop 3
ds_write_b128 v246, a[48:51] offset:49152
ds_write_b128 v246, a[52:55] offset:50176
ds_write_b128 v246, a[56:59] offset:51200
ds_write_b128 v246, a[60:63] offset:52224
v_accvgpr_read_b32 v160, a0
v_accvgpr_read_b32 v161, a1
v_accvgpr_read_b32 v162, a2
v_accvgpr_read_b32 v163, a3
v_accvgpr_read_b32 v164, a4
v_accvgpr_read_b32 v165, a5
v_accvgpr_read_b32 v166, a6
v_accvgpr_read_b32 v167, a7
v_accvgpr_read_b32 v168, a8
v_accvgpr_read_b32 v169, a9
v_accvgpr_read_b32 v170, a10
v_accvgpr_read_b32 v171, a11
v_accvgpr_read_b32 v172, a12
v_accvgpr_read_b32 v173, a13
v_accvgpr_read_b32 v174, a14
v_accvgpr_read_b32 v175, a15
s_waitcnt lgkmcnt(0)
s_barrier
ds_read_b128 v[48:51], v247 offset:49152
ds_read_b128 v[52:55], v247 offset:50176
ds_read_b128 v[56:59], v247 offset:51200
ds_read_b128 v[60:63], v247 offset:52224
ds_read_b128 v[64:67], v247 offset:53248
ds_read_b128 v[68:71], v247 offset:54272
ds_read_b128 v[72:75], v247 offset:55296
ds_read_b128 v[76:79], v247 offset:56320
ds_read_b128 v[80:83], v247 offset:57344
ds_read_b128 v[84:87], v247 offset:58368
ds_read_b128 v[88:91], v247 offset:59392
ds_read_b128 v[92:95], v247 offset:60416
ds_write_b128 v244, a[80:83] offset:0
ds_write_b128 v244, a[84:87] offset:1024
ds_write_b128 v244, a[88:91] offset:2048
ds_write_b128 v244, a[92:95] offset:3072
ds_write_b128 v245, a[96:99] offset:0
ds_write_b128 v245, a[100:103] offset:1024
ds_write_b128 v245, a[104:107] offset:2048
ds_write_b128 v245, a[108:111] offset:3072
ds_write_b128 v246, a[112:115] offset:0
ds_write_b128 v246, a[116:119] offset:1024
ds_write_b128 v246, a[120:123] offset:2048
ds_write_b128 v246, a[124:127] offset:3072
s_waitcnt lgkmcnt(15)
v_pk_add_f32 v[160:161], v[160:161], v[48:49]
v_pk_add_f32 v[162:163], v[162:163], v[50:51]
v_pk_add_f32 v[164:165], v[164:165], v[52:53]
v_pk_add_f32 v[166:167], v[166:167], v[54:55]
v_pk_add_f32 v[168:169], v[168:169], v[56:57]
v_pk_add_f32 v[170:171], v[170:171], v[58:59]
v_pk_add_f32 v[172:173], v[172:173], v[60:61]
v_pk_add_f32 v[174:175], v[174:175], v[62:63]
v_pk_add_f32 v[160:161], v[160:161], v[64:65]
v_pk_add_f32 v[162:163], v[162:163], v[66:67]
v_pk_add_f32 v[164:165], v[164:165], v[68:69]
v_pk_add_f32 v[166:167], v[166:167], v[70:71]
v_pk_add_f32 v[168:169], v[168:169], v[72:73]
v_pk_add_f32 v[170:171], v[170:171], v[74:75]
v_pk_add_f32 v[172:173], v[172:173], v[76:77]
v_pk_add_f32 v[174:175], v[174:175], v[78:79]
v_pk_add_f32 v[160:161], v[160:161], v[80:81]
v_pk_add_f32 v[162:163], v[162:163], v[82:83]
s_waitcnt lgkmcnt(14)
v_pk_add_f32 v[164:165], v[164:165], v[84:85]
v_pk_add_f32 v[166:167], v[166:167], v[86:87]
s_waitcnt lgkmcnt(13)
v_pk_add_f32 v[168:169], v[168:169], v[88:89]
v_pk_add_f32 v[170:171], v[170:171], v[90:91]
s_waitcnt lgkmcnt(12)
v_pk_add_f32 v[172:173], v[172:173], v[92:93]
v_pk_add_f32 v[174:175], v[174:175], v[94:95]
v_mov_b32 v14, v172
v_mov_b32 v15, v172
s_nop 1
v_permlane32_swap_b32 v14, v15
v_med3_f32 v14, v15, s53, v250
v_cmp_neq_f32 vcc, v14, v15
s_cbranch_vccnz F_FB
F_NORM:
v_rcp_f32 v14, v15
s_nop 0
v_pk_mul_f32 v[160:161], v[160:161], v[14:15] op_sel_hi:[1,0]
v_pk_mul_f32 v[162:163], v[162:163], v[14:15] op_sel_hi:[1,0]
v_pk_mul_f32 v[164:165], v[164:165], v[14:15] op_sel_hi:[1,0]
v_pk_mul_f32 v[166:167], v[166:167], v[14:15] op_sel_hi:[1,0]
v_pk_mul_f32 v[168:169], v[168:169], v[14:15] op_sel_hi:[1,0]
v_pk_mul_f32 v[170:171], v[170:171], v[14:15] op_sel_hi:[1,0]
v_pk_mul_f32 v[172:173], v[172:173], v[14:15] op_sel_hi:[1,0]
v_pk_mul_f32 v[174:175], v[174:175], v[14:15] op_sel_hi:[1,0]
v_cvt_pk_bf16_f32 v112, v160, v161
v_cvt_pk_bf16_f32 v113, v162, v163
v_cvt_pk_bf16_f32 v114, v164, v165
v_cvt_pk_bf16_f32 v115, v166, v167
v_min_u32 v112, -2, v112
v_min_u32 v113, -2, v113
v_min_u32 v114, -2, v114
v_min_u32 v115, -2, v115
buffer_store_dwordx4 v[112:115], v0, s[16:19], s71 offen offset:0 sc1
v_cvt_pk_bf16_f32 v116, v168, v169
v_cvt_pk_bf16_f32 v117, v170, v171
v_cvt_pk_bf16_f32 v118, v172, v173
v_cvt_pk_bf16_f32 v119, v174, v175
v_cndmask_b32 v118, 0, v118, s[44:45]
v_cndmask_b32 v119, 0, v119, s[44:45]
v_min_u32 v116, -2, v116
v_min_u32 v117, -2, v117
v_min_u32 v118, -2, v118
v_min_u32 v119, -2, v119
buffer_store_dwordx4 v[116:119], v0, s[16:19], s71 offen offset:2048 sc1
s_cmp_ge_u32 s62, 28
s_cbranch_scc1 F_DONE
v_accvgpr_read_b32 v176, a64
v_accvgpr_read_b32 v177, a65
v_accvgpr_read_b32 v178, a66
v_accvgpr_read_b32 v179, a67
v_accvgpr_read_b32 v180, a68
v_accvgpr_read_b32 v181, a69
v_accvgpr_read_b32 v182, a70
v_accvgpr_read_b32 v183, a71
v_accvgpr_read_b32 v184, a72
v_accvgpr_read_b32 v185, a73
v_accvgpr_read_b32 v186, a74
v_accvgpr_read_b32 v187, a75
v_accvgpr_read_b32 v188, a76
v_accvgpr_read_b32 v189, a77
v_accvgpr_read_b32 v190, a78
v_accvgpr_read_b32 v191, a79
s_waitcnt lgkmcnt(0)
s_barrier
ds_read_b128 v[192:195], v247 offset:0
ds_read_b128 v[196:199], v247 offset:1024
ds_read_b128 v[200:203], v247 offset:2048
ds_read_b128 v[204:207], v247 offset:3072
ds_read_b128 v[208:211], v247 offset:4096
ds_read_b128 v[212:215], v247 offset:5120
ds_read_b128 v[216:219], v247 offset:6144
ds_read_b128 v[220:223], v247 offset:7168
ds_read_b128 v[224:227], v247 offset:8192
ds_read_b128 v[228:231], v247 offset:9216
ds_read_b128 v[232:235], v247 offset:10240
ds_read_b128 v[236:239], v247 offset:11264
buffer_load_dwordx4 v[48:51], v0, s[16:19], s69 offen offset:0 sc1
buffer_load_dwordx4 v[52:55], v0, s[16:19], s69 offen offset:2048 sc1
buffer_load_dwordx4 v[56:59], v1, s[16:19], s69 offen offset:0 sc1
buffer_load_dwordx4 v[60:63], v1, s[16:19], s69 offen offset:2048 sc1
buffer_load_dwordx4 v[64:67], v2, s[16:19], s69 offen offset:0 sc1
buffer_load_dwordx4 v[68:71], v2, s[16:19], s69 offen offset:2048 sc1
buffer_load_dwordx4 v[72:75], v3, s[16:19], s69 offen offset:0 sc1
buffer_load_dwordx4 v[76:79], v3, s[16:19], s69 offen offset:2048 sc1
buffer_load_dwordx4 v[80:83], v0, s[16:19], s70 offen offset:0 sc1
buffer_load_dwordx4 v[84:87], v0, s[16:19], s70 offen offset:2048 sc1
buffer_load_dwordx4 v[88:91], v1, s[16:19], s70 offen offset:0 sc1
buffer_load_dwordx4 v[92:95], v1, s[16:19], s70 offen offset:2048 sc1
buffer_load_dwordx4 v[96:99], v2, s[16:19], s70 offen offset:0 sc1
buffer_load_dwordx4 v[100:103], v2, s[16:19], s70 offen offset:2048 sc1
buffer_load_dwordx4 v[104:107], v3, s[16:19], s70 offen offset:0 sc1
buffer_load_dwordx4 v[108:111], v3, s[16:19], s70 offen offset:2048 sc1
s_mov_b32 s36, 0xbfb8aa3b
s_waitcnt lgkmcnt(11)
v_pk_add_f32 v[176:177], v[176:177], v[192:193]
v_pk_add_f32 v[178:179], v[178:179], v[194:195]
s_waitcnt lgkmcnt(10)
v_pk_add_f32 v[180:181], v[180:181], v[196:197]
v_pk_add_f32 v[182:183], v[182:183], v[198:199]
s_waitcnt lgkmcnt(9)
v_pk_add_f32 v[184:185], v[184:185], v[200:201]
v_pk_add_f32 v[186:187], v[186:187], v[202:203]
s_waitcnt lgkmcnt(8)
v_pk_add_f32 v[188:189], v[188:189], v[204:205]
v_pk_add_f32 v[190:191], v[190:191], v[206:207]
s_waitcnt lgkmcnt(7)
v_pk_add_f32 v[176:177], v[176:177], v[208:209]
v_pk_add_f32 v[178:179], v[178:179], v[210:211]
s_waitcnt lgkmcnt(6)
v_pk_add_f32 v[180:181], v[180:181], v[212:213]
v_pk_add_f32 v[182:183], v[182:183], v[214:215]
s_waitcnt lgkmcnt(5)
v_pk_add_f32 v[184:185], v[184:185], v[216:217]
v_pk_add_f32 v[186:187], v[186:187], v[218:219]
s_waitcnt lgkmcnt(4)
v_pk_add_f32 v[188:189], v[188:189], v[220:221]
v_pk_add_f32 v[190:191], v[190:191], v[222:223]
s_waitcnt lgkmcnt(3)
v_pk_add_f32 v[176:177], v[176:177], v[224:225]
v_pk_add_f32 v[178:179], v[178:179], v[226:227]
s_waitcnt lgkmcnt(2)
v_pk_add_f32 v[180:181], v[180:181], v[228:229]
v_pk_add_f32 v[182:183], v[182:183], v[230:231]
s_waitcnt lgkmcnt(1)
v_pk_add_f32 v[184:185], v[184:185], v[232:233]
v_pk_add_f32 v[186:187], v[186:187], v[234:235]
s_waitcnt lgkmcnt(0)
v_pk_add_f32 v[188:189], v[188:189], v[236:237]
v_pk_add_f32 v[190:191], v[190:191], v[238:239]
ds_read_b128 a[128:131], v253 offset:0
v_mul_f32 v192, s36, v176
v_mul_f32 v193, s36, v177
v_exp_f32 v192, v192
ds_read_b128 a[132:135], v254 offset:0
v_exp_f32 v193, v193
v_add_f32 v192, 1.0, v192
v_add_f32 v193, 1.0, v193
ds_read_b128 a[136:139], v253 offset:2048
v_rcp_f32 v192, v192
v_rcp_f32 v193, v193
v_mul_f32 v176, v176, v192
ds_read_b128 a[140:143], v254 offset:2048
v_mul_f32 v177, v177, v193
v_mul_f32 v194, s36, v178
v_mul_f32 v195, s36, v179
ds_read_b128 a[144:147], v253 offset:4096
v_exp_f32 v194, v194
v_exp_f32 v195, v195
v_add_f32 v194, 1.0, v194
ds_read_b128 a[148:151], v254 offset:4096
v_add_f32 v195, 1.0, v195
v_rcp_f32 v194, v194
v_rcp_f32 v195, v195
ds_read_b128 a[152:155], v253 offset:6144
v_mul_f32 v178, v178, v194
v_mul_f32 v179, v179, v195
v_mul_f32 v196, s36, v180
ds_read_b128 a[156:159], v254 offset:6144
v_mul_f32 v197, s36, v181
v_exp_f32 v196, v196
v_exp_f32 v197, v197
ds_read_b128 a[160:163], v253 offset:8192
v_add_f32 v196, 1.0, v196
v_add_f32 v197, 1.0, v197
v_rcp_f32 v196, v196
ds_read_b128 a[164:167], v254 offset:8192
v_rcp_f32 v197, v197
v_mul_f32 v180, v180, v196
v_mul_f32 v181, v181, v197
ds_read_b128 a[168:171], v253 offset:10240
v_mul_f32 v198, s36, v182
v_mul_f32 v199, s36, v183
v_exp_f32 v198, v198
ds_read_b128 a[172:175], v254 offset:10240
v_exp_f32 v199, v199
v_add_f32 v198, 1.0, v198
v_add_f32 v199, 1.0, v199
ds_read_b128 a[176:179], v253 offset:12288
v_rcp_f32 v198, v198
v_rcp_f32 v199, v199
v_mul_f32 v182, v182, v198
ds_read_b128 a[180:183], v254 offset:12288
v_mul_f32 v183, v183, v199
v_mul_f32 v200, s36, v184
v_mul_f32 v201, s36, v185
ds_read_b128 a[184:187], v253 offset:14336
v_exp_f32 v200, v200
v_exp_f32 v201, v201
v_add_f32 v200, 1.0, v200
ds_read_b128 a[188:191], v254 offset:14336
v_add_f32 v201, 1.0, v201
v_rcp_f32 v200, v200
v_rcp_f32 v201, v201
ds_read_b128 a[192:195], v253 offset:16384
v_mul_f32 v184, v184, v200
v_mul_f32 v185, v185, v201
v_mul_f32 v202, s36, v186
ds_read_b128 a[196:199], v254 offset:16384
v_mul_f32 v203, s36, v187
v_exp_f32 v202, v202
v_exp_f32 v203, v203
ds_read_b128 a[200:203], v253 offset:18432
v_add_f32 v202, 1.0, v202
v_add_f32 v203, 1.0, v203
v_rcp_f32 v202, v202
ds_read_b128 a[204:207], v254 offset:18432
v_rcp_f32 v203, v203
v_mul_f32 v186, v186, v202
v_mul_f32 v187, v187, v203
ds_read_b128 a[208:211], v253 offset:20480
v_mul_f32 v204, s36, v188
v_mul_f32 v205, s36, v189
v_exp_f32 v204, v204
ds_read_b128 a[212:215], v254 offset:20480
v_exp_f32 v205, v205
v_add_f32 v204, 1.0, v204
v_add_f32 v205, 1.0, v205
ds_read_b128 a[216:219], v253 offset:22528
v_rcp_f32 v204, v204
v_rcp_f32 v205, v205
v_mul_f32 v188, v188, v204
ds_read_b128 a[220:223], v254 offset:22528
v_mul_f32 v189, v189, v205
v_mul_f32 v206, s36, v190
v_mul_f32 v207, s36, v191
ds_read_b128 a[224:227], v253 offset:24576
v_exp_f32 v206, v206
v_exp_f32 v207, v207
v_add_f32 v206, 1.0, v206
ds_read_b128 a[228:231], v254 offset:24576
v_add_f32 v207, 1.0, v207
v_rcp_f32 v206, v206
v_rcp_f32 v207, v207
ds_read_b128 a[232:235], v253 offset:26624
v_mul_f32 v190, v190, v206
v_mul_f32 v191, v191, v207
s_waitcnt vmcnt(21)
v_lshlrev_b32 v208, 16, v120
ds_read_b128 a[236:239], v254 offset:26624
v_and_b32 v209, 0xffff0000, v120
v_lshlrev_b32 v210, 16, v121
v_and_b32 v211, 0xffff0000, v121
ds_read_b128 a[240:243], v253 offset:28672
s_waitcnt vmcnt(20)
v_lshlrev_b32 v212, 16, v122
v_and_b32 v213, 0xffff0000, v122
v_lshlrev_b32 v214, 16, v123
ds_read_b128 a[244:247], v254 offset:28672
v_and_b32 v215, 0xffff0000, v123
s_waitcnt vmcnt(19)
v_lshlrev_b32 v216, 16, v124
v_and_b32 v217, 0xffff0000, v124
ds_read_b128 a[248:251], v253 offset:30720
v_lshlrev_b32 v218, 16, v125
v_and_b32 v219, 0xffff0000, v125
s_waitcnt vmcnt(18)
v_lshlrev_b32 v220, 16, v126
ds_read_b128 a[252:255], v254 offset:30720
v_and_b32 v221, 0xffff0000, v126
v_lshlrev_b32 v222, 16, v127
v_and_b32 v223, 0xffff0000, v127
F_CK0:
s_waitcnt vmcnt(15)
v_max3_u32 v13, v48, v49, v50
s_waitcnt vmcnt(14)
v_max3_u32 v14, v51, v52, v53
v_max3_u32 v13, v13, v54, v55
v_max_u32 v13, v13, v14
v_cmp_eq_u32 vcc, -1, v13
s_cbranch_vccnz F_RT0
F_GO0:
s_waitcnt lgkmcnt(15)
v_mfma_f32_32x32x16_bf16 v[144:159], a[132:135], v[48:51], 0
v_mfma_f32_32x32x16_bf16 v[128:143], a[128:131], v[48:51], 0
v_mfma_f32_32x32x16_bf16 v[144:159], a[140:143], v[52:55], v[144:159]
v_mfma_f32_32x32x16_bf16 v[128:143], a[136:139], v[52:55], v[128:143]
F_CK1:
s_waitcnt vmcnt(13)
v_max3_u32 v13, v56, v57, v58
s_waitcnt vmcnt(12)
v_max3_u32 v14, v59, v60, v61
v_max3_u32 v13, v13, v62, v63
v_max_u32 v13, v13, v14
v_cmp_eq_u32 vcc, -1, v13
s_cbranch_vccnz F_RT1
F_GO1:
v_mfma_f32_32x32x16_bf16 v[144:159], a[148:151], v[56:59], v[144:159]
v_mfma_f32_32x32x16_bf16 v[128:143], a[144:147], v[56:59], v[128:143]
v_mfma_f32_32x32x16_bf16 v[144:159], a[156:159], v[60:63], v[144:159]
v_mfma_f32_32x32x16_bf16 v[128:143], a[152:155], v[60:63], v[128:143]
F_CK2:
s_waitcnt vmcnt(11)
v_max3_u32 v13, v64, v65, v66
s_waitcnt vmcnt(10)
v_max3_u32 v14, v67, v68, v69
v_max3_u32 v13, v13, v70, v71
v_max_u32 v13, v13, v14
v_cmp_eq_u32 vcc, -1, v13
s_cbranch_vccnz F_RT2
F_GO2:
v_mfma_f32_32x32x16_bf16 v[144:159], a[164:167], v[64:67], v[144:159]
v_mfma_f32_32x32x16_bf16 v[128:143], a[160:163], v[64:67], v[128:143]
v_mfma_f32_32x32x16_bf16 v[144:159], a[172:175], v[68:71], v[144:159]
v_mfma_f32_32x32x16_bf16 v[128:143], a[168:171], v[68:71], v[128:143]
F_CK3:
s_waitcnt vmcnt(9)
v_max3_u32 v13, v72, v73, v74
s_waitcnt vmcnt(8)
v_max3_u32 v14, v75, v76, v77
v_max3_u32 v13, v13, v78, v79
v_max_u32 v13, v13, v14
v_cmp_eq_u32 vcc, -1, v13
s_cbranch_vccnz F_RT3
F_GO3:
v_mfma_f32_32x32x16_bf16 v[144:159], a[180:183], v[72:75], v[144:159]
v_mfma_f32_32x32x16_bf16 v[128:143], a[176:179], v[72:75], v[128:143]
v_mfma_f32_32x32x16_bf16 v[144:159], a[188:191], v[76:79], v[144:159]
v_mfma_f32_32x32x16_bf16 v[128:143], a[184:187], v[76:79], v[128:143]
F_CK4:
s_waitcnt vmcnt(7)
v_max3_u32 v13, v80, v81, v82
s_waitcnt vmcnt(6)
v_max3_u32 v14, v83, v84, v85
v_max3_u32 v13, v13, v86, v87
v_max_u32 v13, v13, v14
v_cmp_eq_u32 vcc, -1, v13
s_cbranch_vccnz F_RT4
F_GO4:
s_waitcnt lgkmcnt(14)
v_mfma_f32_32x32x16_bf16 v[144:159], a[196:199], v[80:83], v[144:159]
v_mfma_f32_32x32x16_bf16 v[128:143], a[192:195], v[80:83], v[128:143]
s_waitcnt lgkmcnt(12)
v_mfma_f32_32x32x16_bf16 v[144:159], a[204:207], v[84:87], v[144:159]
v_mfma_f32_32x32x16_bf16 v[128:143], a[200:203], v[84:87], v[128:143]
F_CK5:
s_waitcnt vmcnt(5)
v_max3_u32 v13, v88, v89, v90
s_waitcnt vmcnt(4)
v_max3_u32 v14, v91, v92, v93
v_max3_u32 v13, v13, v94, v95
v_max_u32 v13, v13, v14
v_cmp_eq_u32 vcc, -1, v13
s_cbranch_vccnz F_RT5
F_GO5:
s_waitcnt lgkmcnt(10)
v_mfma_f32_32x32x16_bf16 v[144:159], a[212:215], v[88:91], v[144:159]
v_mfma_f32_32x32x16_bf16 v[128:143], a[208:211], v[88:91], v[128:143]
s_waitcnt lgkmcnt(8)
v_mfma_f32_32x32x16_bf16 v[144:159], a[220:223], v[92:95], v[144:159]
v_mfma_f32_32x32x16_bf16 v[128:143], a[216:219], v[92:95], v[128:143]
F_CK6:
s_waitcnt vmcnt(3)
v_max3_u32 v13, v96, v97, v98
s_waitcnt vmcnt(2)
v_max3_u32 v14, v99, v100, v101
v_max3_u32 v13, v13, v102, v103
v_max_u32 v13, v13, v14
v_cmp_eq_u32 vcc, -1, v13
s_cbranch_vccnz F_RT6
F_GO6:
s_waitcnt lgkmcnt(6)
v_mfma_f32_32x32x16_bf16 v[144:159], a[228:231], v[96:99], v[144:159]
v_mfma_f32_32x32x16_bf16 v[128:143], a[224:227], v[96:99], v[128:143]
s_waitcnt lgkmcnt(4)
v_mfma_f32_32x32x16_bf16 v[144:159], a[236:239], v[100:103], v[144:159]
v_mfma_f32_32x32x16_bf16 v[128:143], a[232:235], v[100:103], v[128:143]
F_CK7:
s_waitcnt vmcnt(1)
v_max3_u32 v13, v104, v105, v106
s_waitcnt vmcnt(0)
v_max3_u32 v14, v107, v108, v109
v_max3_u32 v13, v13, v110, v111
v_max_u32 v13, v13, v14
v_cmp_eq_u32 vcc, -1, v13
s_cbranch_vccnz F_RT7
F_GO7:
s_waitcnt lgkmcnt(2)
v_mfma_f32_32x32x16_bf16 v[144:159], a[244:247], v[104:107], v[144:159]
v_mfma_f32_32x32x16_bf16 v[128:143], a[240:243], v[104:107], v[128:143]
s_waitcnt lgkmcnt(0)
v_mfma_f32_32x32x16_bf16 v[144:159], a[252:255], v[108:111], v[144:159]
v_mfma_f32_32x32x16_bf16 v[128:143], a[248:251], v[108:111], v[128:143]
s_nop 10
ds_write_b128 v251, v[144:147] offset:49152
ds_write_b128 v251, v[148:151] offset:50176
ds_write_b128 v251, v[152:155] offset:51200
ds_write_b128 v251, v[156:159] offset:52224
s_waitcnt lgkmcnt(0)
s_barrier
ds_read_b128 v[48:51], v252 offset:49152
ds_read_b128 v[52:55], v252 offset:50176
ds_read_b128 v[56:59], v252 offset:51200
ds_read_b128 v[60:63], v252 offset:52224
s_waitcnt lgkmcnt(3)
v_pk_add_f32 v[128:129], v[128:129], v[48:49]
v_pk_fma_f32 v[128:129], v[128:129], v[176:177], v[208:209]
v_pk_add_f32 v[130:131], v[130:131], v[50:51]
v_pk_fma_f32 v[130:131], v[130:131], v[178:179], v[210:211]
s_waitcnt lgkmcnt(2)
v_pk_add_f32 v[132:133], v[132:133], v[52:53]
v_pk_fma_f32 v[132:133], v[132:133], v[180:181], v[212:213]
v_pk_add_f32 v[134:135], v[134:135], v[54:55]
v_pk_fma_f32 v[134:135], v[134:135], v[182:183], v[214:215]
s_waitcnt lgkmcnt(1)
v_pk_add_f32 v[136:137], v[136:137], v[56:57]
v_pk_fma_f32 v[136:137], v[136:137], v[184:185], v[216:217]
v_pk_add_f32 v[138:139], v[138:139], v[58:59]
v_pk_fma_f32 v[138:139], v[138:139], v[186:187], v[218:219]
s_waitcnt lgkmcnt(0)
v_pk_add_f32 v[140:141], v[140:141], v[60:61]
v_pk_fma_f32 v[140:141], v[140:141], v[188:189], v[220:221]
v_pk_add_f32 v[142:143], v[142:143], v[62:63]
v_pk_fma_f32 v[142:143], v[142:143], v[190:191], v[222:223]
v_cvt_pk_bf16_f32 v112, v128, v129
v_cvt_pk_bf16_f32 v113, v130, v131
v_cvt_pk_bf16_f32 v114, v132, v133
v_cvt_pk_bf16_f32 v115, v134, v135
v_cvt_pk_bf16_f32 v116, v136, v137
v_cvt_pk_bf16_f32 v117, v138, v139
v_cvt_pk_bf16_f32 v118, v140, v141
v_cvt_pk_bf16_f32 v119, v142, v143
v_permlane32_swap_b32 v112, v114
v_permlane32_swap_b32 v113, v115
buffer_store_dwordx4 v[112:115], v249, s[28:31], 0 offen offset:0
v_permlane32_swap_b32 v116, v118
v_permlane32_swap_b32 v117, v119
buffer_store_dwordx4 v[116:119], v249, s[28:31], 0 offen offset:32
F_DONE:
F_END:
s_endpgm
F_RT0:
s_sub_u32 s48, s48, 1
s_cbranch_scc1 F_GV0
buffer_load_dwordx4 v[48:51], v0, s[16:19], s69 offen offset:0 sc1
buffer_load_dwordx4 v[52:55], v0, s[16:19], s69 offen offset:2048 sc1
buffer_load_dwordx4 v[56:59], v1, s[16:19], s69 offen offset:0 sc1
buffer_load_dwordx4 v[60:63], v1, s[16:19], s69 offen offset:2048 sc1
buffer_load_dwordx4 v[64:67], v2, s[16:19], s69 offen offset:0 sc1
buffer_load_dwordx4 v[68:71], v2, s[16:19], s69 offen offset:2048 sc1
buffer_load_dwordx4 v[72:75], v3, s[16:19], s69 offen offset:0 sc1
buffer_load_dwordx4 v[76:79], v3, s[16:19], s69 offen offset:2048 sc1
buffer_load_dwordx4 v[80:83], v0, s[16:19], s70 offen offset:0 sc1
buffer_load_dwordx4 v[84:87], v0, s[16:19], s70 offen offset:2048 sc1
buffer_load_dwordx4 v[88:91], v1, s[16:19], s70 offen offset:0 sc1
buffer_load_dwordx4 v[92:95], v1, s[16:19], s70 offen offset:2048 sc1
buffer_load_dwordx4 v[96:99], v2, s[16:19], s70 offen offset:0 sc1
buffer_load_dwordx4 v[100:103], v2, s[16:19], s70 offen offset:2048 sc1
buffer_load_dwordx4 v[104:107], v3, s[16:19], s70 offen offset:0 sc1
buffer_load_dwordx4 v[108:111], v3, s[16:19], s70 offen offset:2048 sc1
s_branch F_CK0
F_GV0:
s_mov_b32 s48, 0
s_branch F_GO0
F_RT1:
s_sub_u32 s48, s48, 1
s_cbranch_scc1 F_GV1
buffer_load_dwordx4 v[56:59], v1, s[16:19], s69 offen offset:0 sc1
buffer_load_dwordx4 v[60:63], v1, s[16:19], s69 offen offset:2048 sc1
buffer_load_dwordx4 v[64:67], v2, s[16:19], s69 offen offset:0 sc1
buffer_load_dwordx4 v[68:71], v2, s[16:19], s69 offen offset:2048 sc1
buffer_load_dwordx4 v[72:75], v3, s[16:19], s69 offen offset:0 sc1
buffer_load_dwordx4 v[76:79], v3, s[16:19], s69 offen offset:2048 sc1
buffer_load_dwordx4 v[80:83], v0, s[16:19], s70 offen offset:0 sc1
buffer_load_dwordx4 v[84:87], v0, s[16:19], s70 offen offset:2048 sc1
buffer_load_dwordx4 v[88:91], v1, s[16:19], s70 offen offset:0 sc1
buffer_load_dwordx4 v[92:95], v1, s[16:19], s70 offen offset:2048 sc1
buffer_load_dwordx4 v[96:99], v2, s[16:19], s70 offen offset:0 sc1
buffer_load_dwordx4 v[100:103], v2, s[16:19], s70 offen offset:2048 sc1
buffer_load_dwordx4 v[104:107], v3, s[16:19], s70 offen offset:0 sc1
buffer_load_dwordx4 v[108:111], v3, s[16:19], s70 offen offset:2048 sc1
s_branch F_CK1
F_GV1:
s_mov_b32 s48, 0
s_branch F_GO1
F_RT2:
s_sub_u32 s48, s48, 1
s_cbranch_scc1 F_GV2
buffer_load_dwordx4 v[64:67], v2, s[16:19], s69 offen offset:0 sc1
buffer_load_dwordx4 v[68:71], v2, s[16:19], s69 offen offset:2048 sc1
buffer_load_dwordx4 v[72:75], v3, s[16:19], s69 offen offset:0 sc1
buffer_load_dwordx4 v[76:79], v3, s[16:19], s69 offen offset:2048 sc1
buffer_load_dwordx4 v[80:83], v0, s[16:19], s70 offen offset:0 sc1
buffer_load_dwordx4 v[84:87], v0, s[16:19], s70 offen offset:2048 sc1
buffer_load_dwordx4 v[88:91], v1, s[16:19], s70 offen offset:0 sc1
buffer_load_dwordx4 v[92:95], v1, s[16:19], s70 offen offset:2048 sc1
buffer_load_dwordx4 v[96:99], v2, s[16:19], s70 offen offset:0 sc1
buffer_load_dwordx4 v[100:103], v2, s[16:19], s70 offen offset:2048 sc1
buffer_load_dwordx4 v[104:107], v3, s[16:19], s70 offen offset:0 sc1
buffer_load_dwordx4 v[108:111], v3, s[16:19], s70 offen offset:2048 sc1
s_branch F_CK2
F_GV2:
s_mov_b32 s48, 0
s_branch F_GO2
F_RT3:
s_sub_u32 s48, s48, 1
s_cbranch_scc1 F_GV3
buffer_load_dwordx4 v[72:75], v3, s[16:19], s69 offen offset:0 sc1
buffer_load_dwordx4 v[76:79], v3, s[16:19], s69 offen offset:2048 sc1
buffer_load_dwordx4 v[80:83], v0, s[16:19], s70 offen offset:0 sc1
buffer_load_dwordx4 v[84:87], v0, s[16:19], s70 offen offset:2048 sc1
buffer_load_dwordx4 v[88:91], v1, s[16:19], s70 offen offset:0 sc1
buffer_load_dwordx4 v[92:95], v1, s[16:19], s70 offen offset:2048 sc1
buffer_load_dwordx4 v[96:99], v2, s[16:19], s70 offen offset:0 sc1
buffer_load_dwordx4 v[100:103], v2, s[16:19], s70 offen offset:2048 sc1
buffer_load_dwordx4 v[104:107], v3, s[16:19], s70 offen offset:0 sc1
buffer_load_dwordx4 v[108:111], v3, s[16:19], s70 offen offset:2048 sc1
s_branch F_CK3
F_GV3:
s_mov_b32 s48, 0
s_branch F_GO3
F_RT4:
s_sub_u32 s48, s48, 1
s_cbranch_scc1 F_GV4
buffer_load_dwordx4 v[80:83], v0, s[16:19], s70 offen offset:0 sc1
buffer_load_dwordx4 v[84:87], v0, s[16:19], s70 offen offset:2048 sc1
buffer_load_dwordx4 v[88:91], v1, s[16:19], s70 offen offset:0 sc1
buffer_load_dwordx4 v[92:95], v1, s[16:19], s70 offen offset:2048 sc1
buffer_load_dwordx4 v[96:99], v2, s[16:19], s70 offen offset:0 sc1
buffer_load_dwordx4 v[100:103], v2, s[16:19], s70 offen offset:2048 sc1
buffer_load_dwordx4 v[104:107], v3, s[16:19], s70 offen offset:0 sc1
buffer_load_dwordx4 v[108:111], v3, s[16:19], s70 offen offset:2048 sc1
s_branch F_CK4
F_GV4:
s_mov_b32 s48, 0
s_branch F_GO4
F_RT5:
s_sub_u32 s48, s48, 1
s_cbranch_scc1 F_GV5
buffer_load_dwordx4 v[88:91], v1, s[16:19], s70 offen offset:0 sc1
buffer_load_dwordx4 v[92:95], v1, s[16:19], s70 offen offset:2048 sc1
buffer_load_dwordx4 v[96:99], v2, s[16:19], s70 offen offset:0 sc1
buffer_load_dwordx4 v[100:103], v2, s[16:19], s70 offen offset:2048 sc1
buffer_load_dwordx4 v[104:107], v3, s[16:19], s70 offen offset:0 sc1
buffer_load_dwordx4 v[108:111], v3, s[16:19], s70 offen offset:2048 sc1
s_branch F_CK5
F_GV5:
s_mov_b32 s48, 0
s_branch F_GO5
F_RT6:
s_sub_u32 s48, s48, 1
s_cbranch_scc1 F_GV6
buffer_load_dwordx4 v[96:99], v2, s[16:19], s70 offen offset:0 sc1
buffer_load_dwordx4 v[100:103], v2, s[16:19], s70 offen offset:2048 sc1
buffer_load_dwordx4 v[104:107], v3, s[16:19], s70 offen offset:0 sc1
buffer_load_dwordx4 v[108:111], v3, s[16:19], s70 offen offset:2048 sc1
s_branch F_CK6
F_GV6:
s_mov_b32 s48, 0
s_branch F_GO6
F_RT7:
s_sub_u32 s48, s48, 1
s_cbranch_scc1 F_GV7
buffer_load_dwordx4 v[104:107], v3, s[16:19], s70 offen offset:0 sc1
buffer_load_dwordx4 v[108:111], v3, s[16:19], s70 offen offset:2048 sc1
s_branch F_CK7
F_GV7:
s_mov_b32 s48, 0
s_branch F_GO7
F_C_RT:
buffer_load_dword v9, v10, s[16:19], s58 offen sc1
s_waitcnt vmcnt(0)
v_cmp_ne_u32 vcc, 1, v9
s_cbranch_vccz F_C_GO
s_sub_u32 s48, s48, 1
s_cbranch_scc0 F_C_RT
s_mov_b32 s48, 0
s_branch F_C_GO
F_H_RT:
buffer_load_dword v9, v8, s[24:27], s63 offen sc1
s_waitcnt vmcnt(0)
v_cmp_ne_u32 vcc, s60, v9
s_cbranch_vccz F_H_GO
s_sub_u32 s48, s48, 1
s_cbranch_scc0 F_H_RT
s_mov_b32 s48, 0
s_branch F_H_GO
F_FB:
s_mov_b32 s36, s64
s_mov_b32 s37, 64
v_mov_b32 v14, 0xff800000
F_FB1:
buffer_load_dwordx4 v[48:51], v0, s[16:19], s36 offen offset:0 sc1
buffer_load_dwordx4 v[52:55], v0, s[16:19], s36 offen offset:1024 sc1
s_waitcnt vmcnt(1)
v_mfma_f32_32x32x16_bf16 v[128:143], v[48:51], v[16:19], 0
s_waitcnt vmcnt(0)
v_mfma_f32_32x32x16_bf16 v[128:143], v[52:55], v[20:23], v[128:143]
s_nop 11
v_max3_f32 v14, v14, v128, v129
v_max3_f32 v14, v14, v130, v131
v_max3_f32 v14, v14, v132, v133
v_max3_f32 v14, v14, v134, v135
v_max3_f32 v14, v14, v136, v137
v_max3_f32 v14, v14, v138, v139
v_max3_f32 v14, v14, v140, v141
v_max3_f32 v14, v14, v142, v143
s_add_u32 s36, s36, 4096
s_sub_u32 s37, s37, 1
s_cmp_lg_u32 s37, 0
s_cbranch_scc1 F_FB1
v_mov_b32 v15, v14
s_nop 1
v_permlane32_swap_b32 v14, v15
v_max_f32 v14, v14, v15
s_mov_b32 s36, s64
s_mov_b32 s37, 64
v_mov_b32 v160, 0
v_mov_b32 v161, 0
v_mov_b32 v162, 0
v_mov_b32 v163, 0
v_mov_b32 v164, 0
v_mov_b32 v165, 0
v_mov_b32 v166, 0
v_mov_b32 v167, 0
v_mov_b32 v168, 0
v_mov_b32 v169, 0
v_mov_b32 v170, 0
v_mov_b32 v171, 0
v_mov_b32 v172, 0
v_mov_b32 v173, 0
v_mov_b32 v174, 0
v_mov_b32 v175, 0
F_FB2:
buffer_load_dwordx4 v[48:51], v0, s[16:19], s36 offen offset:0 sc1
buffer_load_dwordx4 v[52:55], v0, s[16:19], s36 offen offset:1024 sc1
buffer_load_dwordx4 v[56:59], v0, s[16:19], s36 offen offset:2048 sc1
buffer_load_dwordx4 v[60:63], v0, s[16:19], s36 offen offset:3072 sc1
s_waitcnt vmcnt(3)
v_mfma_f32_32x32x16_bf16 v[128:143], v[48:51], v[16:19], 0
s_waitcnt vmcnt(2)
v_mfma_f32_32x32x16_bf16 v[128:143], v[52:55], v[20:23], v[128:143]
s_nop 11
v_sub_f32 v128, v128, v14
v_sub_f32 v129, v129, v14
v_sub_f32 v130, v130, v14
v_sub_f32 v131, v131, v14
v_sub_f32 v132, v132, v14
v_sub_f32 v133, v133, v14
v_sub_f32 v134, v134, v14
v_sub_f32 v135, v135, v14
v_sub_f32 v136, v136, v14
v_sub_f32 v137, v137, v14
v_sub_f32 v138, v138, v14
v_sub_f32 v139, v139, v14
v_sub_f32 v140, v140, v14
v_sub_f32 v141, v141, v14
v_sub_f32 v142, v142, v14
v_sub_f32 v143, v143, v14
v_exp_f32 v128, v128
v_exp_f32 v129, v129
v_exp_f32 v130, v130
v_exp_f32 v131, v131
v_exp_f32 v132, v132
v_exp_f32 v133, v133
v_exp_f32 v134, v134
v_exp_f32 v135, v135
v_exp_f32 v136, v136
v_exp_f32 v137, v137
v_exp_f32 v138, v138
v_exp_f32 v139, v139
v_exp_f32 v140, v140
v_exp_f32 v141, v141
v_exp_f32 v142, v142
v_exp_f32 v143, v143
v_cvt_pk_bf16_f32 v112, v128, v129
v_cvt_pk_bf16_f32 v113, v130, v131
v_cvt_pk_bf16_f32 v114, v132, v133
v_cvt_pk_bf16_f32 v115, v134, v135
v_cvt_pk_bf16_f32 v116, v136, v137
v_cvt_pk_bf16_f32 v117, v138, v139
v_cvt_pk_bf16_f32 v118, v140, v141
v_cvt_pk_bf16_f32 v119, v142, v143
s_waitcnt vmcnt(1)
v_mfma_f32_32x32x16_bf16 v[160:175], v[56:59], v[112:115], v[160:175]
s_waitcnt vmcnt(0)
v_mfma_f32_32x32x16_bf16 v[160:175], v[60:63], v[116:119], v[160:175]
s_add_u32 s36, s36, 4096
s_sub_u32 s37, s37, 1
s_cmp_lg_u32 s37, 0
s_cbranch_scc1 F_FB2
s_nop 7
v_mov_b32 v14, v172
v_mov_b32 v15, v172
s_nop 1
v_permlane32_swap_b32 v14, v15
s_branch F_NORM
F_LAST:
v_lshlrev_b32 v9, 3, v0
buffer_store_dword v13, v9, s[16:19], s59 offen sc1
s_add_u32 s59, s59, 8192
buffer_store_dword v13, v9, s[16:19], s59 offen sc1
s_add_u32 s59, s59, 8192
buffer_store_dword v13, v9, s[16:19], s59 offen sc1
s_add_u32 s59, s59, 8192
buffer_store_dword v13, v9, s[16:19], s59 offen sc1
s_add_u32 s59, s59, 8192
s_branch F_LAST_GO
F_CODE_END:
s_endpgm
.section .rodata,"a"
.p2align 6
.amdhsa_kernel f_kernel
  .amdhsa_next_free_vgpr 512
  .amdhsa_next_free_sgpr 102
  .amdhsa_accum_offset 256
  .amdhsa_group_segment_fixed_size 0
  .amdhsa_kernarg_size 80
  .amdhsa_user_sgpr_count 2
  .amdhsa_user_sgpr_kernarg_segment_ptr 1
  .amdhsa_system_sgpr_workgroup_id_x 1
.end_amdhsa_kernel
```
